```python
import torch

def _softmax(x, axis=-1):
    return torch.softmax(x, dim=axis)
def _gelu(x):
    return torch.nn.functional.gelu(x, approximate="tanh")
def _silu(x):
    return torch.nn.functional.silu(x)
def _sigmoid(x):
    return torch.sigmoid(x)
def _layernorm(x, axis=-1, eps=1e-5):
    m = x.mean(dim=axis, keepdim=True)
    v = x.var(dim=axis, keepdim=True, unbiased=False)
    return (x - m) / torch.sqrt(v + eps)
def _scatter_add(tgt, idx, src, axis=0):
    return tgt.clone().index_add_(axis, idx, src)
def _segment_sum(src, seg, n):
    out = torch.zeros((n,) + src.shape[1:], dtype=src.dtype)
    return out.index_add_(0, seg, src)
def _pad(x, pw):
    flat = tuple(v for pair in reversed(pw) for v in pair)
    return torch.nn.functional.pad(x, flat)

kernel_name = 'parallel_sum__ssm_conv_s4d__glu_gated_geglu__prompt'

def setup_inputs():

    _w = (lambda a: (lambda t: t.to(torch.bfloat16) if t.is_floating_point() else t)(torch.as_tensor(a)))
    def _A_setup():
        Bsz, L, D, N = 1, 2048, 512, 128
        return {
            "u": _w((lambda *s: torch.randn(*s, dtype=torch.bfloat16) * 0.05)(Bsz, L, D)),
            "log_A_real": _w((lambda *s: torch.randn(*s, dtype=torch.bfloat16) * 6.4)(D, N) * 0.5),
            "A_imag": _w((lambda *s: torch.randn(*s, dtype=torch.bfloat16) * 0.05)(D, N) * 3.14),
            "C_real": _w((lambda *s: torch.randn(*s, dtype=torch.bfloat16) * 0.05)(D, N) / N ** 0.5),
            "C_imag": _w((lambda *s: torch.randn(*s, dtype=torch.bfloat16) * 0.05)(D, N) / N ** 0.5),
            "log_dt": _w((lambda *s: torch.randn(*s, dtype=torch.bfloat16) * 0.05)(D) * 0.5 - 4.0),
            "D_skip": _w((lambda *s: torch.randn(*s, dtype=torch.bfloat16) * 0.05)(D)),
        }
    _A_in = _A_setup()

    def _B_setup():
        B, S, Dm, Df = 1, 2048, 512, 1792
        return {
            "x": _w((lambda *s: torch.randn(*s, dtype=torch.bfloat16) * 0.05)(B, S, Dm)),
            "w_gate": _w((lambda *s: torch.randn(*s, dtype=torch.bfloat16) * 0.4)(Dm, Df) * (Dm ** -0.5)),
            "w_up": _w((lambda *s: torch.randn(*s, dtype=torch.bfloat16) * 0.4)(Dm, Df) * (Dm ** -0.5)),
            "w_down": _w((lambda *s: torch.randn(*s, dtype=torch.bfloat16) * 0.4)(Df, Dm) * (Df ** -0.5)),
        }
    _B_in = _B_setup()

    return {
        "A_u": _A_in["u"],
        "A_log_A_real": _A_in["log_A_real"],
        "A_A_imag": _A_in["A_imag"],
        "A_C_real": _A_in["C_real"],
        "A_C_imag": _A_in["C_imag"],
        "A_log_dt": _A_in["log_dt"],
        "A_D_skip": _A_in["D_skip"],
        "B_x": _B_in["x"],
        "B_w_gate": _B_in["w_gate"],
        "B_w_up": _B_in["w_up"],
        "B_w_down": _B_in["w_down"],
    }

def reference(A_u, A_log_A_real, A_A_imag, A_C_real, A_C_imag, A_log_dt, A_D_skip, B_x, B_w_gate, B_w_up, B_w_down):
    def _A_ref(u, log_A_real, A_imag, C_real, C_imag, log_dt, D_skip):
        L = u.shape[1]
        dt = torch.exp(log_dt)
        A = -torch.exp(log_A_real) + 1j * A_imag
        C = (C_real + 1j * C_imag) * dt[:, None]
        pos = (lambda x, dt: x.to(dt))(torch.arange(L), log_dt.dtype)
        P = torch.exp((A * dt[:, None])[:, :, None] * pos[None, None, :])
        K = 2.0 * torch.einsum("dn,dnl->dl", C, P).real
        L2 = 2 * L
        u_t = (lambda x, *d: x.permute(*d))(u, 0, 2, 1)
        Kf = (lambda x, *a, **k: torch.fft.rfft(x.float(), *a, **k))(K, L2)
        Uf = (lambda x, *a, **k: torch.fft.rfft(x.float(), *a, **k))(u_t, L2)
        y = (lambda x, *a, **k: torch.fft.irfft(x, *a, **k).to(torch.bfloat16))(Uf * Kf[None, :, :], L2)[:, :, :L]
        y = (lambda x, *d: x.permute(*d))(y, 0, 2, 1)
        return y + u * D_skip[None, None, :]

    def _B_ref(x, w_gate, w_up, w_down):
        g = torch.einsum("bsd,df->bsf", x, w_gate)
        u = torch.einsum("bsd,df->bsf", x, w_up)
        h = _gelu(g) * u
        return torch.einsum("bsf,fd->bsd", h, w_down)

    x = A_u
    xn = _layernorm(x, axis=-1)
    return x + _A_ref(xn, A_log_A_real, A_A_imag, A_C_real, A_C_imag, A_log_dt, A_D_skip) + _B_ref(xn, B_w_gate, B_w_up, B_w_down)
```

```asm
; @launch kernel=fused_kernel grid=(512,1,1) block=(256,1,1) lds=81920
.amdgcn_target "amdgcn-amd-amdhsa--gfx950"
.text
.globl fused_kernel
.p2align 8
.type fused_kernel,@function
fused_kernel:
    s_cmp_ge_u32 s2, 512
    s_cbranch_scc1 L_end
    s_load_dwordx2 s[4:5], s[0:1], 0
    s_load_dwordx2 s[6:7], s[0:1], 104
    s_add_u32 s2, s2, 511
    s_and_b32 s2, s2, 511
    v_and_b32 v1, 63, v0
    v_lshrrev_b32 v2, 6, v0
    s_nop 0
    v_readfirstlane_b32 s14, v2
    s_and_b32 s8, s2, 63
    s_lshl_b32 s8, s8, 8
    s_add_u32 s8, s8, 0x2010000
    v_mov_b32 v121, s8
    s_cmp_ge_u32 s2, 256
    s_cbranch_scc1 L_B
    s_setprio 3
    s_cmp_ge_u32 s14, 2
    s_cbranch_scc1 L_A_rl
    v_and_b32 v3, 15, v1
    v_lshrrev_b32 v4, 4, v1
    v_lshl_add_u32 v5, v2, 2, v4
    s_lshl_b32 s8, s2, 13
    v_lshlrev_b32 v6, 10, v5
    v_lshl_add_u32 v6, v3, 6, v6
    v_add_u32 v6, s8, v6
    v_mul_u32_u24 v7, 0x440, v5
    v_lshl_add_u32 v7, v3, 6, v7
    s_waitcnt lgkmcnt(0)
    global_load_dwordx4 v[16:19], v6, s[4:5] offset:0
    global_load_dwordx4 v[20:23], v6, s[4:5] offset:16
    global_load_dwordx4 v[24:27], v6, s[4:5] offset:32
    global_load_dwordx4 v[28:31], v6, s[4:5] offset:48
    global_load_dword v120, v121, s[6:7] sc0 sc1
    s_lshr_b32 s8, s2, 4
    s_lshl_b32 s8, s8, 17
    s_bfe_u32 s9, s2, 0x20002
    s_lshl_b32 s9, s9, 11
    s_add_u32 s8, s8, s9
    s_and_b32 s9, s2, 3
    s_lshl_b32 s9, s9, 7
    s_add_u32 s8, s8, s9
    v_lshlrev_b32 v13, 13, v3
    v_lshl_add_u32 v13, v5, 4, v13
    v_add_u32 v13, s8, v13
    v_lshrrev_b32 v9, 2, v1
    v_and_b32 v9, 3, v9
    v_lshl_add_u32 v9, v2, 2, v9
    v_mul_u32_u24 v9, 0x440, v9
    v_and_b32 v10, 3, v1
    v_lshl_add_u32 v9, v10, 3, v9
    v_lshl_add_u32 v9, v4, 5, v9
    s_lshl_b32 s8, s2, 13
    s_lshl_b32 s9, s14, 12
    s_add_u32 s8, s8, s9
    s_add_u32 s8, s8, 0x200000
    v_lshlrev_b32 v10, 3, v1
    v_add_u32 v10, s8, v10
    s_waitcnt vmcnt(1)
    v_lshlrev_b32 v48, 16, v16
    v_and_b32 v49, 0xffff0000, v16
    v_lshlrev_b32 v50, 16, v17
    v_and_b32 v51, 0xffff0000, v17
    v_lshlrev_b32 v52, 16, v18
    v_and_b32 v53, 0xffff0000, v18
    v_lshlrev_b32 v54, 16, v19
    v_and_b32 v55, 0xffff0000, v19
    v_lshlrev_b32 v56, 16, v20
    v_and_b32 v57, 0xffff0000, v20
    v_lshlrev_b32 v58, 16, v21
    v_and_b32 v59, 0xffff0000, v21
    v_lshlrev_b32 v60, 16, v22
    v_and_b32 v61, 0xffff0000, v22
    v_lshlrev_b32 v62, 16, v23
    v_and_b32 v63, 0xffff0000, v23
    v_lshlrev_b32 v64, 16, v24
    v_and_b32 v65, 0xffff0000, v24
    v_lshlrev_b32 v66, 16, v25
    v_and_b32 v67, 0xffff0000, v25
    v_lshlrev_b32 v68, 16, v26
    v_and_b32 v69, 0xffff0000, v26
    v_lshlrev_b32 v70, 16, v27
    v_and_b32 v71, 0xffff0000, v27
    v_lshlrev_b32 v72, 16, v28
    v_and_b32 v73, 0xffff0000, v28
    v_lshlrev_b32 v74, 16, v29
    v_and_b32 v75, 0xffff0000, v29
    v_lshlrev_b32 v76, 16, v30
    v_and_b32 v77, 0xffff0000, v30
    v_lshlrev_b32 v78, 16, v31
    v_and_b32 v79, 0xffff0000, v31
    v_pk_add_f32 v[80:81], v[48:49], v[50:51]
    v_pk_add_f32 v[82:83], v[52:53], v[54:55]
    v_pk_add_f32 v[80:81], v[80:81], v[56:57]
    v_pk_add_f32 v[82:83], v[82:83], v[58:59]
    v_pk_add_f32 v[80:81], v[80:81], v[60:61]
    v_pk_add_f32 v[82:83], v[82:83], v[62:63]
    v_pk_add_f32 v[80:81], v[80:81], v[64:65]
    v_pk_add_f32 v[82:83], v[82:83], v[66:67]
    v_pk_add_f32 v[80:81], v[80:81], v[68:69]
    v_pk_add_f32 v[82:83], v[82:83], v[70:71]
    v_pk_add_f32 v[80:81], v[80:81], v[72:73]
    v_pk_add_f32 v[82:83], v[82:83], v[74:75]
    v_pk_add_f32 v[80:81], v[80:81], v[76:77]
    v_pk_add_f32 v[82:83], v[82:83], v[78:79]
    v_pk_add_f32 v[80:81], v[80:81], v[82:83]
    v_add_f32 v80, v80, v81
    s_nop 1
    v_add_f32_dpp v81, v80, v80 row_ror:8 row_mask:0xf bank_mask:0xf
    s_nop 1
    v_add_f32_dpp v80, v81, v81 row_ror:4 row_mask:0xf bank_mask:0xf
    s_nop 1
    v_add_f32_dpp v81, v80, v80 row_ror:2 row_mask:0xf bank_mask:0xf
    s_nop 1
    v_add_f32_dpp v80, v81, v81 row_ror:1 row_mask:0xf bank_mask:0xf
    v_mul_f32 v82, 0x3b000000, v80
    v_pk_add_f32 v[88:89], v[48:49], v[82:83] op_sel:[0,0] op_sel_hi:[1,0] neg_lo:[0,1] neg_hi:[0,1]
    v_pk_mul_f32 v[84:85], v[88:89], v[88:89]
    v_pk_add_f32 v[90:91], v[50:51], v[82:83] op_sel:[0,0] op_sel_hi:[1,0] neg_lo:[0,1] neg_hi:[0,1]
    v_pk_mul_f32 v[86:87], v[90:91], v[90:91]
    v_pk_add_f32 v[88:89], v[52:53], v[82:83] op_sel:[0,0] op_sel_hi:[1,0] neg_lo:[0,1] neg_hi:[0,1]
    v_pk_fma_f32 v[84:85], v[88:89], v[88:89], v[84:85]
    v_pk_add_f32 v[90:91], v[54:55], v[82:83] op_sel:[0,0] op_sel_hi:[1,0] neg_lo:[0,1] neg_hi:[0,1]
    v_pk_fma_f32 v[86:87], v[90:91], v[90:91], v[86:87]
    v_pk_add_f32 v[88:89], v[56:57], v[82:83] op_sel:[0,0] op_sel_hi:[1,0] neg_lo:[0,1] neg_hi:[0,1]
    v_pk_fma_f32 v[84:85], v[88:89], v[88:89], v[84:85]
    v_pk_add_f32 v[90:91], v[58:59], v[82:83] op_sel:[0,0] op_sel_hi:[1,0] neg_lo:[0,1] neg_hi:[0,1]
    v_pk_fma_f32 v[86:87], v[90:91], v[90:91], v[86:87]
    v_pk_add_f32 v[88:89], v[60:61], v[82:83] op_sel:[0,0] op_sel_hi:[1,0] neg_lo:[0,1] neg_hi:[0,1]
    v_pk_fma_f32 v[84:85], v[88:89], v[88:89], v[84:85]
    v_pk_add_f32 v[90:91], v[62:63], v[82:83] op_sel:[0,0] op_sel_hi:[1,0] neg_lo:[0,1] neg_hi:[0,1]
    v_pk_fma_f32 v[86:87], v[90:91], v[90:91], v[86:87]
    v_pk_add_f32 v[88:89], v[64:65], v[82:83] op_sel:[0,0] op_sel_hi:[1,0] neg_lo:[0,1] neg_hi:[0,1]
    v_pk_fma_f32 v[84:85], v[88:89], v[88:89], v[84:85]
    v_pk_add_f32 v[90:91], v[66:67], v[82:83] op_sel:[0,0] op_sel_hi:[1,0] neg_lo:[0,1] neg_hi:[0,1]
    v_pk_fma_f32 v[86:87], v[90:91], v[90:91], v[86:87]
    v_pk_add_f32 v[88:89], v[68:69], v[82:83] op_sel:[0,0] op_sel_hi:[1,0] neg_lo:[0,1] neg_hi:[0,1]
    v_pk_fma_f32 v[84:85], v[88:89], v[88:89], v[84:85]
    v_pk_add_f32 v[90:91], v[70:71], v[82:83] op_sel:[0,0] op_sel_hi:[1,0] neg_lo:[0,1] neg_hi:[0,1]
    v_pk_fma_f32 v[86:87], v[90:91], v[90:91], v[86:87]
    v_pk_add_f32 v[88:89], v[72:73], v[82:83] op_sel:[0,0] op_sel_hi:[1,0] neg_lo:[0,1] neg_hi:[0,1]
    v_pk_fma_f32 v[84:85], v[88:89], v[88:89], v[84:85]
    v_pk_add_f32 v[90:91], v[74:75], v[82:83] op_sel:[0,0] op_sel_hi:[1,0] neg_lo:[0,1] neg_hi:[0,1]
    v_pk_fma_f32 v[86:87], v[90:91], v[90:91], v[86:87]
    v_pk_add_f32 v[88:89], v[76:77], v[82:83] op_sel:[0,0] op_sel_hi:[1,0] neg_lo:[0,1] neg_hi:[0,1]
    v_pk_fma_f32 v[84:85], v[88:89], v[88:89], v[84:85]
    v_pk_add_f32 v[90:91], v[78:79], v[82:83] op_sel:[0,0] op_sel_hi:[1,0] neg_lo:[0,1] neg_hi:[0,1]
    v_pk_fma_f32 v[86:87], v[90:91], v[90:91], v[86:87]
    v_pk_add_f32 v[84:85], v[84:85], v[86:87]
    v_add_f32 v84, v84, v85
    s_nop 1
    v_add_f32_dpp v85, v84, v84 row_ror:8 row_mask:0xf bank_mask:0xf
    s_nop 1
    v_add_f32_dpp v84, v85, v85 row_ror:4 row_mask:0xf bank_mask:0xf
    s_nop 1
    v_add_f32_dpp v85, v84, v84 row_ror:2 row_mask:0xf bank_mask:0xf
    s_nop 1
    v_add_f32_dpp v84, v85, v85 row_ror:1 row_mask:0xf bank_mask:0xf
    v_mul_f32 v86, 0x3b000000, v84
    v_cvt_pk_bf16_f32 v82, v82, v86
    v_and_b32 v86, 0xffff0000, v82
    v_lshlrev_b32 v82, 16, v82
    v_add_f32 v86, 0x3727c5ac, v86
    v_cvt_pk_bf16_f32 v86, v86, v86
    v_lshlrev_b32 v86, 16, v86
    v_sqrt_f32 v86, v86
    s_nop 0
    v_cvt_pk_bf16_f32 v86, v86, v86
    v_lshlrev_b32 v86, 16, v86
    v_rcp_f32 v84, v86
    v_pk_add_f32 v[48:49], v[48:49], v[82:83] op_sel:[0,0] op_sel_hi:[1,0] neg_lo:[0,1] neg_hi:[0,1]
    v_cvt_pk_bf16_f32 v88, v48, v49
    v_lshlrev_b32 v48, 16, v88
    v_and_b32 v49, 0xffff0000, v88
    v_pk_mul_f32 v[88:89], v[48:49], v[84:85] op_sel:[0,0] op_sel_hi:[1,0]
    v_pk_fma_f32 v[90:91], v[88:89], v[86:87], v[48:49] op_sel:[0,0,0] op_sel_hi:[1,0,1] neg_lo:[1,0,0] neg_hi:[1,0,0]
    v_pk_fma_f32 v[88:89], v[90:91], v[84:85], v[88:89] op_sel:[0,0,0] op_sel_hi:[1,0,1]
    v_cvt_pk_bf16_f32 v16, v88, v89
    v_pk_add_f32 v[50:51], v[50:51], v[82:83] op_sel:[0,0] op_sel_hi:[1,0] neg_lo:[0,1] neg_hi:[0,1]
    v_cvt_pk_bf16_f32 v92, v50, v51
    v_lshlrev_b32 v50, 16, v92
    v_and_b32 v51, 0xffff0000, v92
    v_pk_mul_f32 v[92:93], v[50:51], v[84:85] op_sel:[0,0] op_sel_hi:[1,0]
    v_pk_fma_f32 v[94:95], v[92:93], v[86:87], v[50:51] op_sel:[0,0,0] op_sel_hi:[1,0,1] neg_lo:[1,0,0] neg_hi:[1,0,0]
    v_pk_fma_f32 v[92:93], v[94:95], v[84:85], v[92:93] op_sel:[0,0,0] op_sel_hi:[1,0,1]
    v_cvt_pk_bf16_f32 v17, v92, v93
    v_pk_add_f32 v[52:53], v[52:53], v[82:83] op_sel:[0,0] op_sel_hi:[1,0] neg_lo:[0,1] neg_hi:[0,1]
    v_cvt_pk_bf16_f32 v88, v52, v53
    v_lshlrev_b32 v52, 16, v88
    v_and_b32 v53, 0xffff0000, v88
    v_pk_mul_f32 v[88:89], v[52:53], v[84:85] op_sel:[0,0] op_sel_hi:[1,0]
    v_pk_fma_f32 v[90:91], v[88:89], v[86:87], v[52:53] op_sel:[0,0,0] op_sel_hi:[1,0,1] neg_lo:[1,0,0] neg_hi:[1,0,0]
    v_pk_fma_f32 v[88:89], v[90:91], v[84:85], v[88:89] op_sel:[0,0,0] op_sel_hi:[1,0,1]
    v_cvt_pk_bf16_f32 v18, v88, v89
    v_pk_add_f32 v[54:55], v[54:55], v[82:83] op_sel:[0,0] op_sel_hi:[1,0] neg_lo:[0,1] neg_hi:[0,1]
    v_cvt_pk_bf16_f32 v92, v54, v55
    v_lshlrev_b32 v54, 16, v92
    v_and_b32 v55, 0xffff0000, v92
    v_pk_mul_f32 v[92:93], v[54:55], v[84:85] op_sel:[0,0] op_sel_hi:[1,0]
    v_pk_fma_f32 v[94:95], v[92:93], v[86:87], v[54:55] op_sel:[0,0,0] op_sel_hi:[1,0,1] neg_lo:[1,0,0] neg_hi:[1,0,0]
    v_pk_fma_f32 v[92:93], v[94:95], v[84:85], v[92:93] op_sel:[0,0,0] op_sel_hi:[1,0,1]
    v_cvt_pk_bf16_f32 v19, v92, v93
    global_store_dwordx4 v13, v[16:19], s[6:7] offset:0 sc0 sc1
    ds_write_b128 v7, v[16:19] offset:0
    v_pk_add_f32 v[56:57], v[56:57], v[82:83] op_sel:[0,0] op_sel_hi:[1,0] neg_lo:[0,1] neg_hi:[0,1]
    v_cvt_pk_bf16_f32 v88, v56, v57
    v_lshlrev_b32 v56, 16, v88
    v_and_b32 v57, 0xffff0000, v88
    v_pk_mul_f32 v[88:89], v[56:57], v[84:85] op_sel:[0,0] op_sel_hi:[1,0]
    v_pk_fma_f32 v[90:91], v[88:89], v[86:87], v[56:57] op_sel:[0,0,0] op_sel_hi:[1,0,1] neg_lo:[1,0,0] neg_hi:[1,0,0]
    v_pk_fma_f32 v[88:89], v[90:91], v[84:85], v[88:89] op_sel:[0,0,0] op_sel_hi:[1,0,1]
    v_cvt_pk_bf16_f32 v20, v88, v89
    v_pk_add_f32 v[58:59], v[58:59], v[82:83] op_sel:[0,0] op_sel_hi:[1,0] neg_lo:[0,1] neg_hi:[0,1]
    v_cvt_pk_bf16_f32 v92, v58, v59
    v_lshlrev_b32 v58, 16, v92
    v_and_b32 v59, 0xffff0000, v92
    v_pk_mul_f32 v[92:93], v[58:59], v[84:85] op_sel:[0,0] op_sel_hi:[1,0]
    v_pk_fma_f32 v[94:95], v[92:93], v[86:87], v[58:59] op_sel:[0,0,0] op_sel_hi:[1,0,1] neg_lo:[1,0,0] neg_hi:[1,0,0]
    v_pk_fma_f32 v[92:93], v[94:95], v[84:85], v[92:93] op_sel:[0,0,0] op_sel_hi:[1,0,1]
    v_cvt_pk_bf16_f32 v21, v92, v93
    v_pk_add_f32 v[60:61], v[60:61], v[82:83] op_sel:[0,0] op_sel_hi:[1,0] neg_lo:[0,1] neg_hi:[0,1]
    v_cvt_pk_bf16_f32 v88, v60, v61
    v_lshlrev_b32 v60, 16, v88
    v_and_b32 v61, 0xffff0000, v88
    v_pk_mul_f32 v[88:89], v[60:61], v[84:85] op_sel:[0,0] op_sel_hi:[1,0]
    v_pk_fma_f32 v[90:91], v[88:89], v[86:87], v[60:61] op_sel:[0,0,0] op_sel_hi:[1,0,1] neg_lo:[1,0,0] neg_hi:[1,0,0]
    v_pk_fma_f32 v[88:89], v[90:91], v[84:85], v[88:89] op_sel:[0,0,0] op_sel_hi:[1,0,1]
    v_cvt_pk_bf16_f32 v22, v88, v89
    v_pk_add_f32 v[62:63], v[62:63], v[82:83] op_sel:[0,0] op_sel_hi:[1,0] neg_lo:[0,1] neg_hi:[0,1]
    v_cvt_pk_bf16_f32 v92, v62, v63
    v_lshlrev_b32 v62, 16, v92
    v_and_b32 v63, 0xffff0000, v92
    v_pk_mul_f32 v[92:93], v[62:63], v[84:85] op_sel:[0,0] op_sel_hi:[1,0]
    v_pk_fma_f32 v[94:95], v[92:93], v[86:87], v[62:63] op_sel:[0,0,0] op_sel_hi:[1,0,1] neg_lo:[1,0,0] neg_hi:[1,0,0]
    v_pk_fma_f32 v[92:93], v[94:95], v[84:85], v[92:93] op_sel:[0,0,0] op_sel_hi:[1,0,1]
    v_cvt_pk_bf16_f32 v23, v92, v93
    global_store_dwordx4 v13, v[20:23], s[6:7] offset:512 sc0 sc1
    ds_write_b128 v7, v[20:23] offset:16
    v_pk_add_f32 v[64:65], v[64:65], v[82:83] op_sel:[0,0] op_sel_hi:[1,0] neg_lo:[0,1] neg_hi:[0,1]
    v_cvt_pk_bf16_f32 v88, v64, v65
    v_lshlrev_b32 v64, 16, v88
    v_and_b32 v65, 0xffff0000, v88
    v_pk_mul_f32 v[88:89], v[64:65], v[84:85] op_sel:[0,0] op_sel_hi:[1,0]
    v_pk_fma_f32 v[90:91], v[88:89], v[86:87], v[64:65] op_sel:[0,0,0] op_sel_hi:[1,0,1] neg_lo:[1,0,0] neg_hi:[1,0,0]
    v_pk_fma_f32 v[88:89], v[90:91], v[84:85], v[88:89] op_sel:[0,0,0] op_sel_hi:[1,0,1]
    v_cvt_pk_bf16_f32 v24, v88, v89
    v_pk_add_f32 v[66:67], v[66:67], v[82:83] op_sel:[0,0] op_sel_hi:[1,0] neg_lo:[0,1] neg_hi:[0,1]
    v_cvt_pk_bf16_f32 v92, v66, v67
    v_lshlrev_b32 v66, 16, v92
    v_and_b32 v67, 0xffff0000, v92
    v_pk_mul_f32 v[92:93], v[66:67], v[84:85] op_sel:[0,0] op_sel_hi:[1,0]
    v_pk_fma_f32 v[94:95], v[92:93], v[86:87], v[66:67] op_sel:[0,0,0] op_sel_hi:[1,0,1] neg_lo:[1,0,0] neg_hi:[1,0,0]
    v_pk_fma_f32 v[92:93], v[94:95], v[84:85], v[92:93] op_sel:[0,0,0] op_sel_hi:[1,0,1]
    v_cvt_pk_bf16_f32 v25, v92, v93
    v_pk_add_f32 v[68:69], v[68:69], v[82:83] op_sel:[0,0] op_sel_hi:[1,0] neg_lo:[0,1] neg_hi:[0,1]
    v_cvt_pk_bf16_f32 v88, v68, v69
    v_lshlrev_b32 v68, 16, v88
    v_and_b32 v69, 0xffff0000, v88
    v_pk_mul_f32 v[88:89], v[68:69], v[84:85] op_sel:[0,0] op_sel_hi:[1,0]
    v_pk_fma_f32 v[90:91], v[88:89], v[86:87], v[68:69] op_sel:[0,0,0] op_sel_hi:[1,0,1] neg_lo:[1,0,0] neg_hi:[1,0,0]
    v_pk_fma_f32 v[88:89], v[90:91], v[84:85], v[88:89] op_sel:[0,0,0] op_sel_hi:[1,0,1]
    v_cvt_pk_bf16_f32 v26, v88, v89
    v_pk_add_f32 v[70:71], v[70:71], v[82:83] op_sel:[0,0] op_sel_hi:[1,0] neg_lo:[0,1] neg_hi:[0,1]
    v_cvt_pk_bf16_f32 v92, v70, v71
    v_lshlrev_b32 v70, 16, v92
    v_and_b32 v71, 0xffff0000, v92
    v_pk_mul_f32 v[92:93], v[70:71], v[84:85] op_sel:[0,0] op_sel_hi:[1,0]
    v_pk_fma_f32 v[94:95], v[92:93], v[86:87], v[70:71] op_sel:[0,0,0] op_sel_hi:[1,0,1] neg_lo:[1,0,0] neg_hi:[1,0,0]
    v_pk_fma_f32 v[92:93], v[94:95], v[84:85], v[92:93] op_sel:[0,0,0] op_sel_hi:[1,0,1]
    v_cvt_pk_bf16_f32 v27, v92, v93
    global_store_dwordx4 v13, v[24:27], s[6:7] offset:1024 sc0 sc1
    ds_write_b128 v7, v[24:27] offset:32
    v_pk_add_f32 v[72:73], v[72:73], v[82:83] op_sel:[0,0] op_sel_hi:[1,0] neg_lo:[0,1] neg_hi:[0,1]
    v_cvt_pk_bf16_f32 v88, v72, v73
    v_lshlrev_b32 v72, 16, v88
    v_and_b32 v73, 0xffff0000, v88
    v_pk_mul_f32 v[88:89], v[72:73], v[84:85] op_sel:[0,0] op_sel_hi:[1,0]
    v_pk_fma_f32 v[90:91], v[88:89], v[86:87], v[72:73] op_sel:[0,0,0] op_sel_hi:[1,0,1] neg_lo:[1,0,0] neg_hi:[1,0,0]
    v_pk_fma_f32 v[88:89], v[90:91], v[84:85], v[88:89] op_sel:[0,0,0] op_sel_hi:[1,0,1]
    v_cvt_pk_bf16_f32 v28, v88, v89
    v_pk_add_f32 v[74:75], v[74:75], v[82:83] op_sel:[0,0] op_sel_hi:[1,0] neg_lo:[0,1] neg_hi:[0,1]
    v_cvt_pk_bf16_f32 v92, v74, v75
    v_lshlrev_b32 v74, 16, v92
    v_and_b32 v75, 0xffff0000, v92
    v_pk_mul_f32 v[92:93], v[74:75], v[84:85] op_sel:[0,0] op_sel_hi:[1,0]
    v_pk_fma_f32 v[94:95], v[92:93], v[86:87], v[74:75] op_sel:[0,0,0] op_sel_hi:[1,0,1] neg_lo:[1,0,0] neg_hi:[1,0,0]
    v_pk_fma_f32 v[92:93], v[94:95], v[84:85], v[92:93] op_sel:[0,0,0] op_sel_hi:[1,0,1]
    v_cvt_pk_bf16_f32 v29, v92, v93
    v_pk_add_f32 v[76:77], v[76:77], v[82:83] op_sel:[0,0] op_sel_hi:[1,0] neg_lo:[0,1] neg_hi:[0,1]
    v_cvt_pk_bf16_f32 v88, v76, v77
    v_lshlrev_b32 v76, 16, v88
    v_and_b32 v77, 0xffff0000, v88
    v_pk_mul_f32 v[88:89], v[76:77], v[84:85] op_sel:[0,0] op_sel_hi:[1,0]
    v_pk_fma_f32 v[90:91], v[88:89], v[86:87], v[76:77] op_sel:[0,0,0] op_sel_hi:[1,0,1] neg_lo:[1,0,0] neg_hi:[1,0,0]
    v_pk_fma_f32 v[88:89], v[90:91], v[84:85], v[88:89] op_sel:[0,0,0] op_sel_hi:[1,0,1]
    v_cvt_pk_bf16_f32 v30, v88, v89
    v_pk_add_f32 v[78:79], v[78:79], v[82:83] op_sel:[0,0] op_sel_hi:[1,0] neg_lo:[0,1] neg_hi:[0,1]
    v_cvt_pk_bf16_f32 v92, v78, v79
    v_lshlrev_b32 v78, 16, v92
    v_and_b32 v79, 0xffff0000, v92
    v_pk_mul_f32 v[92:93], v[78:79], v[84:85] op_sel:[0,0] op_sel_hi:[1,0]
    v_pk_fma_f32 v[94:95], v[92:93], v[86:87], v[78:79] op_sel:[0,0,0] op_sel_hi:[1,0,1] neg_lo:[1,0,0] neg_hi:[1,0,0]
    v_pk_fma_f32 v[92:93], v[94:95], v[84:85], v[92:93] op_sel:[0,0,0] op_sel_hi:[1,0,1]
    v_cvt_pk_bf16_f32 v31, v92, v93
    global_store_dwordx4 v13, v[28:31], s[6:7] offset:1536 sc0 sc1
    ds_write_b128 v7, v[28:31] offset:48
    s_waitcnt lgkmcnt(0)
    ds_read_b64_tr_b16 v[48:49], v9 offset:0
    ds_read_b64_tr_b16 v[50:51], v9 offset:128
    ds_read_b64_tr_b16 v[52:53], v9 offset:256
    ds_read_b64_tr_b16 v[54:55], v9 offset:384
    ds_read_b64_tr_b16 v[56:57], v9 offset:512
    ds_read_b64_tr_b16 v[58:59], v9 offset:640
    ds_read_b64_tr_b16 v[60:61], v9 offset:768
    ds_read_b64_tr_b16 v[62:63], v9 offset:896
    s_waitcnt lgkmcnt(7)
    global_store_dwordx2 v10, v[48:49], s[6:7] offset:0 sc0 sc1
    s_waitcnt lgkmcnt(6)
    global_store_dwordx2 v10, v[50:51], s[6:7] offset:512 sc0 sc1
    s_waitcnt lgkmcnt(5)
    global_store_dwordx2 v10, v[52:53], s[6:7] offset:1024 sc0 sc1
    s_waitcnt lgkmcnt(4)
    global_store_dwordx2 v10, v[54:55], s[6:7] offset:1536 sc0 sc1
    s_waitcnt lgkmcnt(3)
    global_store_dwordx2 v10, v[56:57], s[6:7] offset:2048 sc0 sc1
    s_waitcnt lgkmcnt(2)
    global_store_dwordx2 v10, v[58:59], s[6:7] offset:2560 sc0 sc1
    s_waitcnt lgkmcnt(1)
    global_store_dwordx2 v10, v[60:61], s[6:7] offset:3072 sc0 sc1
    s_waitcnt lgkmcnt(0)
    global_store_dwordx2 v10, v[62:63], s[6:7] offset:3584 sc0 sc1
    s_cmp_lg_u32 s14, 0
    s_cbranch_scc1 L_A_p1w
    s_mov_b32 s96, 0
L_A_hs:
    global_load_dword v122, v121, s[6:7] sc0 sc1
    s_waitcnt vmcnt(0)
    v_cmp_ne_u32 vcc, v122, v120
    s_cbranch_vccnz L_A_hs_ok
    s_add_u32 s96, s96, 1
    s_cmp_lt_u32 s96, 131072
    s_cbranch_scc0 L_A_hs_ok
    s_sleep 1
    s_branch L_A_hs
L_A_hs_ok:
    s_branch L_A_p1w
L_A_rl:
    s_cmp_ge_u32 s2, 224
    s_cbranch_scc1 L_A_p1w
    s_and_b32 s8, s2, 3
    s_lshl_b32 s8, s8, 2
    s_bfe_u32 s9, s2, 0x20003
    s_or_b32 s8, s8, s9
    s_bfe_u32 s9, s2, 0x10002
    s_mul_i32 s9, s9, 7
    s_lshr_b32 s10, s2, 5
    s_add_u32 s9, s9, s10
    s_lshl_b32 s3, s9, 4
    s_add_u32 s3, s3, s8
    s_and_b32 s8, s14, 1
    s_mul_i32 s8, s8, 224
    s_add_u32 s3, s3, s8
    s_mov_b32 s95, 0
L_rl:
    s_load_dwordx4 s[8:11], s[0:1], 64
    s_load_dwordx2 s[12:13], s[0:1], 80
    v_lshrrev_b32 v3, 4, v1
    v_and_b32 v4, 15, v1
    v_lshrrev_b32 v5, 2, v1
    v_and_b32 v5, 3, v5
    v_and_b32 v6, 3, v1
    v_and_b32 v7, 1, v3
    v_lshrrev_b32 v8, 1, v3
    v_and_b32 v9, 1, v6
    v_lshrrev_b32 v10, 1, v6
    s_waitcnt lgkmcnt(0)
    s_cmp_ge_u32 s3, 448
    s_cbranch_scc1 L_rl_d
    s_cmp_ge_u32 s3, 224
    s_cselect_b32 s8, s10, s8
    s_cselect_b32 s9, s11, s9
    s_cselect_b32 s15, 1, 0
    s_cselect_b32 s16, 224, 0
    s_sub_u32 s25, s3, s16
    s_lshr_b32 s16, s25, 4
    s_and_b32 s17, s25, 15
    s_mul_i32 s18, s17, 114688
    s_lshl_b32 s19, s16, 8
    s_add_u32 s18, s18, s19
    s_add_u32 s8, s8, s18
    s_addc_u32 s9, s9, 0
    s_lshl_b32 s18, s25, 1
    s_add_u32 s18, s18, s15
    s_lshl_b32 s18, s18, 13
    s_add_u32 s18, s18, 0x1400000
    s_movk_i32 s19, 3584
    s_movk_i32 s20, 4096
    s_movk_i32 s21, 2048
    s_movk_i32 s22, 1024
    v_lshlrev_b32 v11, 2, v7
    v_lshl_add_u32 v11, v9, 1, v11
    v_add_u32 v11, v11, v10
    s_branch L_rl_go
L_rl_d:
    s_sub_u32 s25, s3, 448
    s_lshr_b32 s16, s25, 2
    s_and_b32 s17, s25, 3
    s_lshl_b32 s18, s16, 15
    s_lshl_b32 s19, s17, 8
    s_add_u32 s18, s18, s19
    s_add_u32 s8, s12, s18
    s_addc_u32 s9, s13, 0
    s_mul_i32 s18, s17, 458752
    s_lshl_b32 s19, s16, 12
    s_add_u32 s18, s18, s19
    s_add_u32 s18, s18, 0x1800000
    s_movk_i32 s19, 1024
    s_mov_b32 s20, 229376
    s_movk_i32 s21, 1024
    s_movk_i32 s22, 2048
    v_lshlrev_b32 v11, 2, v9
    v_lshl_add_u32 v11, v7, 1, v11
    v_add_u32 v11, v11, v10
L_rl_go:
    v_mul_lo_u32 v12, v3, s19
    v_lshl_add_u32 v12, v4, 4, v12
    s_lshl_b32 s23, s19, 2
    s_mul_i32 s24, s14, 8704
    v_mul_u32_u24 v13, 272, v3
    v_lshl_add_u32 v13, v4, 4, v13
    v_add_u32 v13, s24, v13
    global_load_dwordx4 v[16:19], v12, s[8:9]
    v_add_u32 v12, s23, v12
    global_load_dwordx4 v[20:23], v12, s[8:9]
    v_add_u32 v12, s23, v12
    global_load_dwordx4 v[24:27], v12, s[8:9]
    v_add_u32 v12, s23, v12
    global_load_dwordx4 v[28:31], v12, s[8:9]
    v_add_u32 v12, s23, v12
    global_load_dwordx4 v[32:35], v12, s[8:9]
    v_add_u32 v12, s23, v12
    global_load_dwordx4 v[36:39], v12, s[8:9]
    v_add_u32 v12, s23, v12
    global_load_dwordx4 v[40:43], v12, s[8:9]
    v_add_u32 v12, s23, v12
    global_load_dwordx4 v[44:47], v12, s[8:9]
    v_lshl_add_u32 v14, v8, 3, v5
    v_mul_u32_u24 v14, 272, v14
    v_lshl_add_u32 v14, v11, 3, v14
    v_add_u32 v14, s24, v14
    v_lshlrev_b32 v15, 4, v1
    v_add_u32 v15, s18, v15
    s_waitcnt vmcnt(7)
    ds_write_b128 v13, v[16:19] offset:0
    s_waitcnt vmcnt(6)
    ds_write_b128 v13, v[20:23] offset:1088
    s_waitcnt vmcnt(5)
    ds_write_b128 v13, v[24:27] offset:2176
    s_waitcnt vmcnt(4)
    ds_write_b128 v13, v[28:31] offset:3264
    s_waitcnt vmcnt(3)
    ds_write_b128 v13, v[32:35] offset:4352
    s_waitcnt vmcnt(2)
    ds_write_b128 v13, v[36:39] offset:5440
    s_waitcnt vmcnt(1)
    ds_write_b128 v13, v[40:43] offset:6528
    s_waitcnt vmcnt(0)
    ds_write_b128 v13, v[44:47] offset:7616
    s_waitcnt lgkmcnt(0)
    ds_read_b64_tr_b16 v[48:49], v14 offset:0
    ds_read_b64_tr_b16 v[50:51], v14 offset:1088
    ds_read_b64_tr_b16 v[52:53], v14 offset:4352
    ds_read_b64_tr_b16 v[54:55], v14 offset:5440
    ds_read_b64_tr_b16 v[56:57], v14 offset:64
    ds_read_b64_tr_b16 v[58:59], v14 offset:1152
    ds_read_b64_tr_b16 v[60:61], v14 offset:4416
    ds_read_b64_tr_b16 v[62:63], v14 offset:5504
    ds_read_b64_tr_b16 v[64:65], v14 offset:128
    ds_read_b64_tr_b16 v[66:67], v14 offset:1216
    ds_read_b64_tr_b16 v[68:69], v14 offset:4480
    ds_read_b64_tr_b16 v[70:71], v14 offset:5568
    ds_read_b64_tr_b16 v[72:73], v14 offset:192
    ds_read_b64_tr_b16 v[74:75], v14 offset:1280
    ds_read_b64_tr_b16 v[76:77], v14 offset:4544
    ds_read_b64_tr_b16 v[78:79], v14 offset:5632
    v_add_u32 v16, s21, v15
    v_add_u32 v17, s20, v15
    v_add_u32 v18, s21, v17
    v_add_u32 v19, s22, v15
    v_add_u32 v20, s22, v16
    v_add_u32 v21, s22, v17
    v_add_u32 v22, s22, v18
    s_waitcnt lgkmcnt(14)
    global_store_dwordx4 v15, v[48:51], s[6:7] sc0 sc1
    s_waitcnt lgkmcnt(12)
    global_store_dwordx4 v19, v[52:55], s[6:7] sc0 sc1
    s_waitcnt lgkmcnt(10)
    global_store_dwordx4 v16, v[56:59], s[6:7] sc0 sc1
    s_waitcnt lgkmcnt(8)
    global_store_dwordx4 v20, v[60:63], s[6:7] sc0 sc1
    s_waitcnt lgkmcnt(6)
    global_store_dwordx4 v17, v[64:67], s[6:7] sc0 sc1
    s_waitcnt lgkmcnt(4)
    global_store_dwordx4 v21, v[68:71], s[6:7] sc0 sc1
    s_waitcnt lgkmcnt(2)
    global_store_dwordx4 v18, v[72:75], s[6:7] sc0 sc1
    s_waitcnt lgkmcnt(0)
    global_store_dwordx4 v22, v[76:79], s[6:7] sc0 sc1
    s_cmp_lg_u32 s95, 0
    s_cbranch_scc1 L_wd_next
L_A_p1w:
    s_waitcnt vmcnt(0) lgkmcnt(0)
    s_barrier
    s_cmp_lg_u32 s14, 0
    s_cbranch_scc1 L_A_p1f
    s_lshl_b32 s8, s2, 2
    s_add_u32 s8, s8, 0x2000800
    v_mov_b32 v3, s8
    v_mov_b32 v4, 1
    global_store_dword v3, v4, s[6:7] offset:-2048 sc0 sc1
    global_store_dword v3, v4, s[6:7] offset:2048 sc0 sc1
L_A_p1f:
    s_setprio 1
    s_cmp_lt_u32 s2, 224
    s_cbranch_scc1 L_G1
    s_sub_u32 s3, s2, 224
    s_mul_i32 s3, s3, 7
    s_add_u32 s3, s3, s14
    s_add_u32 s3, s3, 448
    s_mov_b32 s95, 1
    s_branch L_rl
L_wd_next:
    s_cmp_eq_u32 s95, 2
    s_cbranch_scc1 L_wd_done
    s_cmp_eq_u32 s14, 3
    s_cbranch_scc1 L_wd_done
    s_add_u32 s3, s3, 4
    s_mov_b32 s95, 2
    s_waitcnt vmcnt(0)
    s_branch L_rl
L_wd_done:
    s_waitcnt vmcnt(0) lgkmcnt(0)
    s_barrier
    s_cmp_lg_u32 s14, 0
    s_cbranch_scc1 L_wd_f
    s_lshl_b32 s8, s2, 2
    s_add_u32 s8, s8, 0x2000080
    v_mov_b32 v3, s8
    v_mov_b32 v4, 1
    global_store_dword v3, v4, s[6:7] sc0 sc1
L_wd_f:
    s_lshr_b32 s26, s2, 5
    s_mul_i32 s26, s26, 112
    s_mul_i32 s27, s14, 28
    s_add_u32 s26, s26, s27
    s_lshl_b32 s26, s26, 11
    s_add_u32 s26, s26, 0x1800000
    s_add_u32 s30, s6, s26
    s_addc_u32 s31, s7, 0
    s_add_u32 s26, s30, 16384
    s_addc_u32 s27, s31, 0
    s_mul_i32 s28, s14, 20480
    s_lshr_b32 s29, s14, 1
    s_lshl_b32 s29, s29, 10
    v_and_b32 v8, 31, v1
    v_lshlrev_b32 v8, 2, v8
    v_add_u32 v8, 0x2000400, v8
    v_lshlrev_b32 v3, 4, v1
    v_lshl_add_u32 v4, v1, 4, s29
    v_xor_b32 v5, 0x400, v4
    s_mov_b32 s96, 0
L_sp_f2:
    global_load_dword v9, v8, s[6:7] sc0 sc1
    s_waitcnt vmcnt(0)
    v_cmp_ne_u32 vcc, 1, v9
    s_cbranch_vccz L_sp_f2_ok
    s_add_u32 s96, s96, 1
    s_cmp_lt_u32 s96, 131072
    s_cbranch_scc0 L_sp_f2_ok
    s_sleep 8
    s_branch L_sp_f2
L_sp_f2_ok:
    global_load_dwordx4 v[64:67], v4, s[30:31] offset:0
    global_load_dwordx4 v[68:71], v5, s[30:31] offset:0
    global_load_dwordx4 v[72:75], v4, s[30:31] offset:2048
    global_load_dwordx4 v[76:79], v5, s[30:31] offset:2048
    s_add_u32 s30, s30, 4096
    s_addc_u32 s31, s31, 0
    global_load_dwordx4 v[80:83], v4, s[30:31] offset:0
    global_load_dwordx4 v[84:87], v5, s[30:31] offset:0
    global_load_dwordx4 v[88:91], v4, s[30:31] offset:2048
    global_load_dwordx4 v[92:95], v5, s[30:31] offset:2048
    s_add_u32 s30, s30, 4096
    s_addc_u32 s31, s31, 0
    global_load_dwordx4 v[96:99], v4, s[30:31] offset:0
    global_load_dwordx4 v[100:103], v5, s[30:31] offset:0
    global_load_dwordx4 v[104:107], v4, s[30:31] offset:2048
    global_load_dwordx4 v[108:111], v5, s[30:31] offset:2048
    s_add_u32 s30, s30, 4096
    s_addc_u32 s31, s31, 0
    global_load_dwordx4 v[112:115], v4, s[30:31] offset:0
    global_load_dwordx4 v[116:119], v5, s[30:31] offset:0
    global_load_dwordx4 v[120:123], v4, s[30:31] offset:2048
    global_load_dwordx4 v[124:127], v5, s[30:31] offset:2048
    s_add_u32 s30, s30, 4096
    s_addc_u32 s31, s31, 0
    s_add_u32 m0, s28, 0
    s_nop 0
    global_load_lds_dwordx4 v3, s[26:27] offset:0
    global_load_lds_dwordx4 v3, s[26:27] offset:1024
    global_load_lds_dwordx4 v3, s[26:27] offset:2048
    global_load_lds_dwordx4 v3, s[26:27] offset:3072
    s_add_u32 s26, s26, 4096
    s_addc_u32 s27, s27, 0
    s_add_u32 m0, s28, 4096
    s_nop 0
    global_load_lds_dwordx4 v3, s[26:27] offset:0
    global_load_lds_dwordx4 v3, s[26:27] offset:1024
    global_load_lds_dwordx4 v3, s[26:27] offset:2048
    global_load_lds_dwordx4 v3, s[26:27] offset:3072
    s_add_u32 s26, s26, 4096
    s_addc_u32 s27, s27, 0
    s_add_u32 m0, s28, 8192
    s_nop 0
    global_load_lds_dwordx4 v3, s[26:27] offset:0
    global_load_lds_dwordx4 v3, s[26:27] offset:1024
    global_load_lds_dwordx4 v3, s[26:27] offset:2048
    global_load_lds_dwordx4 v3, s[26:27] offset:3072
    s_add_u32 s26, s26, 4096
    s_addc_u32 s27, s27, 0
    s_add_u32 m0, s28, 12288
    s_nop 0
    global_load_lds_dwordx4 v3, s[26:27] offset:0
    global_load_lds_dwordx4 v3, s[26:27] offset:1024
    global_load_lds_dwordx4 v3, s[26:27] offset:2048
    global_load_lds_dwordx4 v3, s[26:27] offset:3072
    s_add_u32 s26, s26, 4096
    s_addc_u32 s27, s27, 0
    s_add_u32 m0, s28, 16384
    s_nop 0
    global_load_lds_dwordx4 v3, s[26:27] offset:0
    global_load_lds_dwordx4 v3, s[26:27] offset:1024
    global_load_lds_dwordx4 v3, s[26:27] offset:2048
    global_load_lds_dwordx4 v3, s[26:27] offset:3072
    s_add_u32 s26, s26, 4096
    s_addc_u32 s27, s27, 0
    s_waitcnt vmcnt(0)
    s_branch L_G2
L_pf_slow:
    s_mov_b32 s96, 0
L_g1_f2:
    global_load_dword v9, v8, s[6:7] sc0 sc1
    s_waitcnt vmcnt(0)
    v_cmp_ne_u32 vcc, 1, v9
    s_cbranch_vccz L_g1_f2_ok
    s_add_u32 s96, s96, 1
    s_cmp_lt_u32 s96, 131072
    s_cbranch_scc0 L_g1_f2_ok
    s_sleep 2
    s_branch L_g1_f2
L_g1_f2_ok:
    s_branch L_pf_ok
L_G1:
    s_mov_b32 s3, s14
    s_and_b32 s4, s2, 3
    s_lshl_b32 s4, s4, 2
    s_bfe_u32 s8, s2, 0x20003
    s_or_b32 s4, s4, s8
    s_bfe_u32 s5, s2, 0x10002
    s_mul_i32 s5, s5, 7
    s_lshr_b32 s8, s2, 5
    s_add_u32 s5, s5, s8
    v_and_b32 v3, 15, v1
    s_lshl_b32 s8, s4, 4
    v_add_u32 v4, s8, v3
    v_lshrrev_b32 v5, 2, v3
    v_and_b32 v6, 3, v3
    v_lshl_add_u32 v5, v6, 3, v5
    s_and_b32 s8, s2, 0xe4
    v_or_b32 v5, s8, v5
    v_and_b32 v6, 16, v1
    v_cmp_eq_u32 vcc, 0, v6
    s_nop 1
    v_cndmask_b32 v4, v5, v4, vcc
    v_lshlrev_b32 v4, 2, v4
    v_add_u32 v8, 0x2000000, v4
    v_lshlrev_b32 v3, 4, v1
    v_and_b32 v4, 1, v2
    v_lshl_add_u32 v4, v4, 12, v3
    v_lshl_add_u32 v5, v2, 12, v3
    s_lshl_b32 s8, s4, 17
    s_lshl_b32 s9, s5, 18
    s_add_u32 s9, s9, 0x1400000
    s_lshl_b32 s15, s3, 12
    s_add_u32 s10, s6, s8
    s_addc_u32 s11, s7, 0
    s_add_u32 s12, s6, s9
    s_addc_u32 s13, s7, 0
    v_lshrrev_b32 v7, 1, v2
    v_lshl_add_u32 v7, v7, 12, v3
    v_add_u32 v6, 0x10000, v7
    v_mov_b32 v128, 0
    v_mov_b32 v129, 0
    v_mov_b32 v130, 0
    v_mov_b32 v131, 0
    v_mov_b32 v132, 0
    v_mov_b32 v133, 0
    v_mov_b32 v134, 0
    v_mov_b32 v135, 0
    v_mov_b32 v136, 0
    v_mov_b32 v137, 0
    v_mov_b32 v138, 0
    v_mov_b32 v139, 0
    v_mov_b32 v140, 0
    v_mov_b32 v141, 0
    v_mov_b32 v142, 0
    v_mov_b32 v143, 0
    v_mov_b32 v144, 0
    v_mov_b32 v145, 0
    v_mov_b32 v146, 0
    v_mov_b32 v147, 0
    v_mov_b32 v148, 0
    v_mov_b32 v149, 0
    v_mov_b32 v150, 0
    v_mov_b32 v151, 0
    v_mov_b32 v152, 0
    v_mov_b32 v153, 0
    v_mov_b32 v154, 0
    v_mov_b32 v155, 0
    v_mov_b32 v156, 0
    v_mov_b32 v157, 0
    v_mov_b32 v158, 0
    v_mov_b32 v159, 0
    v_mov_b32 v160, 0
    v_mov_b32 v161, 0
    v_mov_b32 v162, 0
    v_mov_b32 v163, 0
    v_mov_b32 v164, 0
    v_mov_b32 v165, 0
    v_mov_b32 v166, 0
    v_mov_b32 v167, 0
    v_mov_b32 v168, 0
    v_mov_b32 v169, 0
    v_mov_b32 v170, 0
    v_mov_b32 v171, 0
    v_mov_b32 v172, 0
    v_mov_b32 v173, 0
    v_mov_b32 v174, 0
    v_mov_b32 v175, 0
    v_mov_b32 v176, 0
    v_mov_b32 v177, 0
    v_mov_b32 v178, 0
    v_mov_b32 v179, 0
    v_mov_b32 v180, 0
    v_mov_b32 v181, 0
    v_mov_b32 v182, 0
    v_mov_b32 v183, 0
    v_mov_b32 v184, 0
    v_mov_b32 v185, 0
    v_mov_b32 v186, 0
    v_mov_b32 v187, 0
    v_mov_b32 v188, 0
    v_mov_b32 v189, 0
    v_mov_b32 v190, 0
    v_mov_b32 v191, 0
    v_mov_b32 v192, 0
    v_mov_b32 v193, 0
    v_mov_b32 v194, 0
    v_mov_b32 v195, 0
    v_mov_b32 v196, 0
    v_mov_b32 v197, 0
    v_mov_b32 v198, 0
    v_mov_b32 v199, 0
    v_mov_b32 v200, 0
    v_mov_b32 v201, 0
    v_mov_b32 v202, 0
    v_mov_b32 v203, 0
    v_mov_b32 v204, 0
    v_mov_b32 v205, 0
    v_mov_b32 v206, 0
    v_mov_b32 v207, 0
    v_mov_b32 v208, 0
    v_mov_b32 v209, 0
    v_mov_b32 v210, 0
    v_mov_b32 v211, 0
    v_mov_b32 v212, 0
    v_mov_b32 v213, 0
    v_mov_b32 v214, 0
    v_mov_b32 v215, 0
    v_mov_b32 v216, 0
    v_mov_b32 v217, 0
    v_mov_b32 v218, 0
    v_mov_b32 v219, 0
    v_mov_b32 v220, 0
    v_mov_b32 v221, 0
    v_mov_b32 v222, 0
    v_mov_b32 v223, 0
    v_mov_b32 v224, 0
    v_mov_b32 v225, 0
    v_mov_b32 v226, 0
    v_mov_b32 v227, 0
    v_mov_b32 v228, 0
    v_mov_b32 v229, 0
    v_mov_b32 v230, 0
    v_mov_b32 v231, 0
    v_mov_b32 v232, 0
    v_mov_b32 v233, 0
    v_mov_b32 v234, 0
    v_mov_b32 v235, 0
    v_mov_b32 v236, 0
    v_mov_b32 v237, 0
    v_mov_b32 v238, 0
    v_mov_b32 v239, 0
    v_mov_b32 v240, 0
    v_mov_b32 v241, 0
    v_mov_b32 v242, 0
    v_mov_b32 v243, 0
    v_mov_b32 v244, 0
    v_mov_b32 v245, 0
    v_mov_b32 v246, 0
    v_mov_b32 v247, 0
    v_mov_b32 v248, 0
    v_mov_b32 v249, 0
    v_mov_b32 v250, 0
    v_mov_b32 v251, 0
    v_mov_b32 v252, 0
    v_mov_b32 v253, 0
    v_mov_b32 v254, 0
    v_mov_b32 v255, 0
    s_mov_b32 s96, 0
L_G1_poll:
    global_load_dword v9, v8, s[6:7] sc0 sc1
    s_waitcnt vmcnt(0)
    v_cmp_ne_u32 vcc, 1, v9
    s_cbranch_vccz L_G1_poll_ok
    s_add_u32 s96, s96, 1
    s_cmp_lt_u32 s96, 131072
    s_cbranch_scc0 L_G1_poll_ok
    s_sleep 2
    s_branch L_G1_poll
L_G1_poll_ok:
    s_lshr_b32 s26, s2, 5
    s_mul_i32 s26, s26, 112
    s_mul_i32 s27, s14, 28
    s_add_u32 s26, s26, s27
    s_lshl_b32 s26, s26, 11
    s_add_u32 s26, s26, 0x1800000
    s_add_u32 s30, s6, s26
    s_addc_u32 s31, s7, 0
    s_add_u32 s26, s30, 16384
    s_addc_u32 s27, s31, 0
    s_mul_i32 s28, s14, 20480
    s_lshr_b32 s29, s14, 1
    s_lshl_b32 s29, s29, 10
    v_and_b32 v8, 31, v1
    v_lshlrev_b32 v8, 2, v8
    v_add_u32 v8, 0x2000400, v8
    s_add_u32 m0, s15, 0
    s_nop 0
    global_load_lds_dwordx4 v5, s[12:13]
    global_load_lds_dwordx4 v5, s[12:13] offset:1024
    global_load_lds_dwordx4 v5, s[12:13] offset:2048
    global_load_lds_dwordx4 v5, s[12:13] offset:3072
    s_add_u32 s12, s12, 16384
    s_addc_u32 s13, s13, 0
    global_load_dwordx4 v[48:51], v4, s[10:11] offset:0
    global_load_dwordx4 v[52:55], v4, s[10:11] offset:2048
    global_load_dwordx4 v[56:59], v4, s[10:11] offset:1024
    global_load_dwordx4 v[60:63], v4, s[10:11] offset:3072
    s_add_u32 s10, s10, 8192
    s_addc_u32 s11, s11, 0
    s_add_u32 m0, s15, 16384
    s_nop 0
    global_load_lds_dwordx4 v5, s[12:13]
    global_load_lds_dwordx4 v5, s[12:13] offset:1024
    global_load_lds_dwordx4 v5, s[12:13] offset:2048
    global_load_lds_dwordx4 v5, s[12:13] offset:3072
    s_add_u32 s12, s12, 16384
    s_addc_u32 s13, s13, 0
    global_load_dwordx4 v[64:67], v4, s[10:11] offset:0
    global_load_dwordx4 v[68:71], v4, s[10:11] offset:2048
    global_load_dwordx4 v[72:75], v4, s[10:11] offset:1024
    global_load_dwordx4 v[76:79], v4, s[10:11] offset:3072
    s_add_u32 s10, s10, 8192
    s_addc_u32 s11, s11, 0
    s_add_u32 m0, s15, 32768
    s_nop 0
    global_load_lds_dwordx4 v5, s[12:13]
    global_load_lds_dwordx4 v5, s[12:13] offset:1024
    global_load_lds_dwordx4 v5, s[12:13] offset:2048
    global_load_lds_dwordx4 v5, s[12:13] offset:3072
    s_add_u32 s12, s12, 16384
    s_addc_u32 s13, s13, 0
    global_load_dwordx4 v[80:83], v4, s[10:11] offset:0
    global_load_dwordx4 v[84:87], v4, s[10:11] offset:2048
    global_load_dwordx4 v[88:91], v4, s[10:11] offset:1024
    global_load_dwordx4 v[92:95], v4, s[10:11] offset:3072
    s_add_u32 s10, s10, 8192
    s_addc_u32 s11, s11, 0
    s_add_u32 m0, s15, 49152
    s_nop 0
    global_load_lds_dwordx4 v5, s[12:13]
    global_load_lds_dwordx4 v5, s[12:13] offset:1024
    global_load_lds_dwordx4 v5, s[12:13] offset:2048
    global_load_lds_dwordx4 v5, s[12:13] offset:3072
    s_add_u32 s12, s12, 16384
    s_addc_u32 s13, s13, 0
    global_load_dwordx4 v[96:99], v4, s[10:11] offset:0
    global_load_dwordx4 v[100:103], v4, s[10:11] offset:2048
    global_load_dwordx4 v[104:107], v4, s[10:11] offset:1024
    global_load_dwordx4 v[108:111], v4, s[10:11] offset:3072
    s_add_u32 s10, s10, 8192
    s_addc_u32 s11, s11, 0
    s_waitcnt vmcnt(24)
    s_barrier
    ds_read_b128 v[16:19], v7 offset:0
    ds_read_b128 v[20:23], v7 offset:2048
    ds_read_b128 v[24:27], v7 offset:8192
    ds_read_b128 v[28:31], v7 offset:10240
    ds_read_b128 v[32:35], v7 offset:1024
    ds_read_b128 v[36:39], v7 offset:3072
    ds_read_b128 v[40:43], v7 offset:9216
    ds_read_b128 v[44:47], v7 offset:11264
    s_waitcnt lgkmcnt(4)
    v_mfma_f32_32x32x16_bf16 v[128:143], v[16:19], v[48:51], v[128:143]
    v_mfma_f32_32x32x16_bf16 v[144:159], v[16:19], v[52:55], v[144:159]
    v_mfma_f32_32x32x16_bf16 v[160:175], v[20:23], v[48:51], v[160:175]
    v_mfma_f32_32x32x16_bf16 v[176:191], v[20:23], v[52:55], v[176:191]
    v_mfma_f32_32x32x16_bf16 v[192:207], v[24:27], v[48:51], v[192:207]
    v_mfma_f32_32x32x16_bf16 v[208:223], v[24:27], v[52:55], v[208:223]
    v_mfma_f32_32x32x16_bf16 v[224:239], v[28:31], v[48:51], v[224:239]
    v_mfma_f32_32x32x16_bf16 v[240:255], v[28:31], v[52:55], v[240:255]
    s_waitcnt vmcnt(16) lgkmcnt(0)
    s_barrier
    ds_read_b128 v[16:19], v7 offset:16384
    ds_read_b128 v[20:23], v7 offset:18432
    ds_read_b128 v[24:27], v7 offset:24576
    ds_read_b128 v[28:31], v7 offset:26624
    v_mfma_f32_32x32x16_bf16 v[128:143], v[32:35], v[56:59], v[128:143]
    s_add_u32 m0, s15, 65536
    s_nop 0
    global_load_lds_dwordx4 v5, s[12:13]
    v_mfma_f32_32x32x16_bf16 v[144:159], v[32:35], v[60:63], v[144:159]
    global_load_lds_dwordx4 v5, s[12:13] offset:1024
    v_mfma_f32_32x32x16_bf16 v[160:175], v[36:39], v[56:59], v[160:175]
    global_load_lds_dwordx4 v5, s[12:13] offset:2048
    v_mfma_f32_32x32x16_bf16 v[176:191], v[36:39], v[60:63], v[176:191]
    global_load_lds_dwordx4 v5, s[12:13] offset:3072
    s_add_u32 s12, s12, 16384
    s_addc_u32 s13, s13, 0
    v_mfma_f32_32x32x16_bf16 v[192:207], v[40:43], v[56:59], v[192:207]
    global_load_dwordx4 v[112:115], v4, s[10:11] offset:0
    v_mfma_f32_32x32x16_bf16 v[208:223], v[40:43], v[60:63], v[208:223]
    global_load_dwordx4 v[116:119], v4, s[10:11] offset:2048
    v_mfma_f32_32x32x16_bf16 v[224:239], v[44:47], v[56:59], v[224:239]
    global_load_dwordx4 v[120:123], v4, s[10:11] offset:1024
    v_mfma_f32_32x32x16_bf16 v[240:255], v[44:47], v[60:63], v[240:255]
    global_load_dwordx4 v[124:127], v4, s[10:11] offset:3072
    s_add_u32 s10, s10, 8192
    s_addc_u32 s11, s11, 0
    ds_read_b128 v[32:35], v7 offset:17408
    ds_read_b128 v[36:39], v7 offset:19456
    ds_read_b128 v[40:43], v7 offset:25600
    ds_read_b128 v[44:47], v7 offset:27648
    s_waitcnt lgkmcnt(4)
    v_mfma_f32_32x32x16_bf16 v[128:143], v[16:19], v[64:67], v[128:143]
    s_add_u32 m0, s15, 0
    s_nop 0
    global_load_lds_dwordx4 v5, s[12:13]
    v_mfma_f32_32x32x16_bf16 v[144:159], v[16:19], v[68:71], v[144:159]
    global_load_lds_dwordx4 v5, s[12:13] offset:1024
    v_mfma_f32_32x32x16_bf16 v[160:175], v[20:23], v[64:67], v[160:175]
    global_load_lds_dwordx4 v5, s[12:13] offset:2048
    v_mfma_f32_32x32x16_bf16 v[176:191], v[20:23], v[68:71], v[176:191]
    global_load_lds_dwordx4 v5, s[12:13] offset:3072
    s_add_u32 s12, s12, 16384
    s_addc_u32 s13, s13, 0
    v_mfma_f32_32x32x16_bf16 v[192:207], v[24:27], v[64:67], v[192:207]
    global_load_dwordx4 v[48:51], v4, s[10:11] offset:0
    v_mfma_f32_32x32x16_bf16 v[208:223], v[24:27], v[68:71], v[208:223]
    global_load_dwordx4 v[52:55], v4, s[10:11] offset:2048
    v_mfma_f32_32x32x16_bf16 v[224:239], v[28:31], v[64:67], v[224:239]
    global_load_dwordx4 v[56:59], v4, s[10:11] offset:1024
    v_mfma_f32_32x32x16_bf16 v[240:255], v[28:31], v[68:71], v[240:255]
    global_load_dwordx4 v[60:63], v4, s[10:11] offset:3072
    s_add_u32 s10, s10, 8192
    s_addc_u32 s11, s11, 0
    s_waitcnt vmcnt(24) lgkmcnt(0)
    s_barrier
    ds_read_b128 v[16:19], v7 offset:32768
    ds_read_b128 v[20:23], v7 offset:34816
    ds_read_b128 v[24:27], v7 offset:40960
    ds_read_b128 v[28:31], v7 offset:43008
    v_mfma_f32_32x32x16_bf16 v[128:143], v[32:35], v[72:75], v[128:143]
    v_mfma_f32_32x32x16_bf16 v[144:159], v[32:35], v[76:79], v[144:159]
    v_mfma_f32_32x32x16_bf16 v[160:175], v[36:39], v[72:75], v[160:175]
    v_mfma_f32_32x32x16_bf16 v[176:191], v[36:39], v[76:79], v[176:191]
    v_mfma_f32_32x32x16_bf16 v[192:207], v[40:43], v[72:75], v[192:207]
    v_mfma_f32_32x32x16_bf16 v[208:223], v[40:43], v[76:79], v[208:223]
    v_mfma_f32_32x32x16_bf16 v[224:239], v[44:47], v[72:75], v[224:239]
    v_mfma_f32_32x32x16_bf16 v[240:255], v[44:47], v[76:79], v[240:255]
    ds_read_b128 v[32:35], v7 offset:33792
    ds_read_b128 v[36:39], v7 offset:35840
    ds_read_b128 v[40:43], v7 offset:41984
    ds_read_b128 v[44:47], v7 offset:44032
    s_waitcnt lgkmcnt(4)
    v_mfma_f32_32x32x16_bf16 v[128:143], v[16:19], v[80:83], v[128:143]
    s_add_u32 m0, s15, 16384
    s_nop 0
    global_load_lds_dwordx4 v5, s[12:13]
    v_mfma_f32_32x32x16_bf16 v[144:159], v[16:19], v[84:87], v[144:159]
    global_load_lds_dwordx4 v5, s[12:13] offset:1024
    v_mfma_f32_32x32x16_bf16 v[160:175], v[20:23], v[80:83], v[160:175]
    global_load_lds_dwordx4 v5, s[12:13] offset:2048
    v_mfma_f32_32x32x16_bf16 v[176:191], v[20:23], v[84:87], v[176:191]
    global_load_lds_dwordx4 v5, s[12:13] offset:3072
    s_add_u32 s12, s12, 16384
    s_addc_u32 s13, s13, 0
    v_mfma_f32_32x32x16_bf16 v[192:207], v[24:27], v[80:83], v[192:207]
    global_load_dwordx4 v[64:67], v4, s[10:11] offset:0
    v_mfma_f32_32x32x16_bf16 v[208:223], v[24:27], v[84:87], v[208:223]
    global_load_dwordx4 v[68:71], v4, s[10:11] offset:2048
    v_mfma_f32_32x32x16_bf16 v[224:239], v[28:31], v[80:83], v[224:239]
    global_load_dwordx4 v[72:75], v4, s[10:11] offset:1024
    v_mfma_f32_32x32x16_bf16 v[240:255], v[28:31], v[84:87], v[240:255]
    global_load_dwordx4 v[76:79], v4, s[10:11] offset:3072
    s_add_u32 s10, s10, 8192
    s_addc_u32 s11, s11, 0
    s_waitcnt vmcnt(24) lgkmcnt(0)
    s_barrier
    ds_read_b128 v[16:19], v7 offset:49152
    ds_read_b128 v[20:23], v7 offset:51200
    ds_read_b128 v[24:27], v7 offset:57344
    ds_read_b128 v[28:31], v7 offset:59392
    v_mfma_f32_32x32x16_bf16 v[128:143], v[32:35], v[88:91], v[128:143]
    v_mfma_f32_32x32x16_bf16 v[144:159], v[32:35], v[92:95], v[144:159]
    v_mfma_f32_32x32x16_bf16 v[160:175], v[36:39], v[88:91], v[160:175]
    v_mfma_f32_32x32x16_bf16 v[176:191], v[36:39], v[92:95], v[176:191]
    v_mfma_f32_32x32x16_bf16 v[192:207], v[40:43], v[88:91], v[192:207]
    v_mfma_f32_32x32x16_bf16 v[208:223], v[40:43], v[92:95], v[208:223]
    v_mfma_f32_32x32x16_bf16 v[224:239], v[44:47], v[88:91], v[224:239]
    v_mfma_f32_32x32x16_bf16 v[240:255], v[44:47], v[92:95], v[240:255]
    ds_read_b128 v[32:35], v7 offset:50176
    ds_read_b128 v[36:39], v7 offset:52224
    ds_read_b128 v[40:43], v7 offset:58368
    ds_read_b128 v[44:47], v7 offset:60416
    s_waitcnt lgkmcnt(4)
    v_mfma_f32_32x32x16_bf16 v[128:143], v[16:19], v[96:99], v[128:143]
    s_add_u32 m0, s15, 32768
    s_nop 0
    global_load_lds_dwordx4 v5, s[12:13]
    v_mfma_f32_32x32x16_bf16 v[144:159], v[16:19], v[100:103], v[144:159]
    global_load_lds_dwordx4 v5, s[12:13] offset:1024
    v_mfma_f32_32x32x16_bf16 v[160:175], v[20:23], v[96:99], v[160:175]
    global_load_lds_dwordx4 v5, s[12:13] offset:2048
    v_mfma_f32_32x32x16_bf16 v[176:191], v[20:23], v[100:103], v[176:191]
    global_load_lds_dwordx4 v5, s[12:13] offset:3072
    s_add_u32 s12, s12, 16384
    s_addc_u32 s13, s13, 0
    v_mfma_f32_32x32x16_bf16 v[192:207], v[24:27], v[96:99], v[192:207]
    global_load_dwordx4 v[80:83], v4, s[10:11] offset:0
    v_mfma_f32_32x32x16_bf16 v[208:223], v[24:27], v[100:103], v[208:223]
    global_load_dwordx4 v[84:87], v4, s[10:11] offset:2048
    v_mfma_f32_32x32x16_bf16 v[224:239], v[28:31], v[96:99], v[224:239]
    global_load_dwordx4 v[88:91], v4, s[10:11] offset:1024
    v_mfma_f32_32x32x16_bf16 v[240:255], v[28:31], v[100:103], v[240:255]
    global_load_dwordx4 v[92:95], v4, s[10:11] offset:3072
    s_add_u32 s10, s10, 8192
    s_addc_u32 s11, s11, 0
    s_waitcnt vmcnt(24) lgkmcnt(0)
    s_barrier
    ds_read_b128 v[16:19], v6 offset:0
    ds_read_b128 v[20:23], v6 offset:2048
    ds_read_b128 v[24:27], v6 offset:8192
    ds_read_b128 v[28:31], v6 offset:10240
    v_mfma_f32_32x32x16_bf16 v[128:143], v[32:35], v[104:107], v[128:143]
    v_mfma_f32_32x32x16_bf16 v[144:159], v[32:35], v[108:111], v[144:159]
    v_mfma_f32_32x32x16_bf16 v[160:175], v[36:39], v[104:107], v[160:175]
    v_mfma_f32_32x32x16_bf16 v[176:191], v[36:39], v[108:111], v[176:191]
    v_mfma_f32_32x32x16_bf16 v[192:207], v[40:43], v[104:107], v[192:207]
    v_mfma_f32_32x32x16_bf16 v[208:223], v[40:43], v[108:111], v[208:223]
    v_mfma_f32_32x32x16_bf16 v[224:239], v[44:47], v[104:107], v[224:239]
    v_mfma_f32_32x32x16_bf16 v[240:255], v[44:47], v[108:111], v[240:255]
    ds_read_b128 v[32:35], v6 offset:1024
    ds_read_b128 v[36:39], v6 offset:3072
    ds_read_b128 v[40:43], v6 offset:9216
    ds_read_b128 v[44:47], v6 offset:11264
    s_waitcnt lgkmcnt(4)
    v_mfma_f32_32x32x16_bf16 v[128:143], v[16:19], v[112:115], v[128:143]
    s_add_u32 m0, s15, 49152
    s_nop 0
    global_load_lds_dwordx4 v5, s[12:13]
    v_mfma_f32_32x32x16_bf16 v[144:159], v[16:19], v[116:119], v[144:159]
    global_load_lds_dwordx4 v5, s[12:13] offset:1024
    v_mfma_f32_32x32x16_bf16 v[160:175], v[20:23], v[112:115], v[160:175]
    global_load_lds_dwordx4 v5, s[12:13] offset:2048
    v_mfma_f32_32x32x16_bf16 v[176:191], v[20:23], v[116:119], v[176:191]
    global_load_lds_dwordx4 v5, s[12:13] offset:3072
    s_add_u32 s12, s12, 16384
    s_addc_u32 s13, s13, 0
    v_mfma_f32_32x32x16_bf16 v[192:207], v[24:27], v[112:115], v[192:207]
    global_load_dwordx4 v[96:99], v4, s[10:11] offset:0
    v_mfma_f32_32x32x16_bf16 v[208:223], v[24:27], v[116:119], v[208:223]
    global_load_dwordx4 v[100:103], v4, s[10:11] offset:2048
    v_mfma_f32_32x32x16_bf16 v[224:239], v[28:31], v[112:115], v[224:239]
    global_load_dwordx4 v[104:107], v4, s[10:11] offset:1024
    v_mfma_f32_32x32x16_bf16 v[240:255], v[28:31], v[116:119], v[240:255]
    global_load_dwordx4 v[108:111], v4, s[10:11] offset:3072
    s_add_u32 s10, s10, 8192
    s_addc_u32 s11, s11, 0
    s_waitcnt vmcnt(24) lgkmcnt(0)
    s_barrier
    ds_read_b128 v[16:19], v7 offset:0
    ds_read_b128 v[20:23], v7 offset:2048
    ds_read_b128 v[24:27], v7 offset:8192
    ds_read_b128 v[28:31], v7 offset:10240
    v_mfma_f32_32x32x16_bf16 v[128:143], v[32:35], v[120:123], v[128:143]
    v_mfma_f32_32x32x16_bf16 v[144:159], v[32:35], v[124:127], v[144:159]
    v_mfma_f32_32x32x16_bf16 v[160:175], v[36:39], v[120:123], v[160:175]
    v_mfma_f32_32x32x16_bf16 v[176:191], v[36:39], v[124:127], v[176:191]
    v_mfma_f32_32x32x16_bf16 v[192:207], v[40:43], v[120:123], v[192:207]
    v_mfma_f32_32x32x16_bf16 v[208:223], v[40:43], v[124:127], v[208:223]
    v_mfma_f32_32x32x16_bf16 v[224:239], v[44:47], v[120:123], v[224:239]
    v_mfma_f32_32x32x16_bf16 v[240:255], v[44:47], v[124:127], v[240:255]
    ds_read_b128 v[32:35], v7 offset:1024
    ds_read_b128 v[36:39], v7 offset:3072
    ds_read_b128 v[40:43], v7 offset:9216
    ds_read_b128 v[44:47], v7 offset:11264
    s_waitcnt lgkmcnt(4)
    v_mfma_f32_32x32x16_bf16 v[128:143], v[16:19], v[48:51], v[128:143]
    s_add_u32 m0, s15, 65536
    s_nop 0
    global_load_lds_dwordx4 v5, s[12:13]
    v_mfma_f32_32x32x16_bf16 v[144:159], v[16:19], v[52:55], v[144:159]
    global_load_lds_dwordx4 v5, s[12:13] offset:1024
    v_mfma_f32_32x32x16_bf16 v[160:175], v[20:23], v[48:51], v[160:175]
    global_load_lds_dwordx4 v5, s[12:13] offset:2048
    v_mfma_f32_32x32x16_bf16 v[176:191], v[20:23], v[52:55], v[176:191]
    global_load_lds_dwordx4 v5, s[12:13] offset:3072
    s_add_u32 s12, s12, 16384
    s_addc_u32 s13, s13, 0
    v_mfma_f32_32x32x16_bf16 v[192:207], v[24:27], v[48:51], v[192:207]
    global_load_dwordx4 v[112:115], v4, s[10:11] offset:0
    v_mfma_f32_32x32x16_bf16 v[208:223], v[24:27], v[52:55], v[208:223]
    global_load_dwordx4 v[116:119], v4, s[10:11] offset:2048
    v_mfma_f32_32x32x16_bf16 v[224:239], v[28:31], v[48:51], v[224:239]
    global_load_dwordx4 v[120:123], v4, s[10:11] offset:1024
    v_mfma_f32_32x32x16_bf16 v[240:255], v[28:31], v[52:55], v[240:255]
    global_load_dwordx4 v[124:127], v4, s[10:11] offset:3072
    s_add_u32 s10, s10, 8192
    s_addc_u32 s11, s11, 0
    s_waitcnt vmcnt(24) lgkmcnt(0)
    s_barrier
    ds_read_b128 v[16:19], v7 offset:16384
    ds_read_b128 v[20:23], v7 offset:18432
    ds_read_b128 v[24:27], v7 offset:24576
    ds_read_b128 v[28:31], v7 offset:26624
    v_mfma_f32_32x32x16_bf16 v[128:143], v[32:35], v[56:59], v[128:143]
    v_mfma_f32_32x32x16_bf16 v[144:159], v[32:35], v[60:63], v[144:159]
    v_mfma_f32_32x32x16_bf16 v[160:175], v[36:39], v[56:59], v[160:175]
    v_mfma_f32_32x32x16_bf16 v[176:191], v[36:39], v[60:63], v[176:191]
    v_mfma_f32_32x32x16_bf16 v[192:207], v[40:43], v[56:59], v[192:207]
    v_mfma_f32_32x32x16_bf16 v[208:223], v[40:43], v[60:63], v[208:223]
    v_mfma_f32_32x32x16_bf16 v[224:239], v[44:47], v[56:59], v[224:239]
    v_mfma_f32_32x32x16_bf16 v[240:255], v[44:47], v[60:63], v[240:255]
    ds_read_b128 v[32:35], v7 offset:17408
    ds_read_b128 v[36:39], v7 offset:19456
    ds_read_b128 v[40:43], v7 offset:25600
    ds_read_b128 v[44:47], v7 offset:27648
    s_waitcnt lgkmcnt(4)
    v_mfma_f32_32x32x16_bf16 v[128:143], v[16:19], v[64:67], v[128:143]
    s_add_u32 m0, s15, 0
    s_nop 0
    global_load_lds_dwordx4 v5, s[12:13]
    v_mfma_f32_32x32x16_bf16 v[144:159], v[16:19], v[68:71], v[144:159]
    global_load_lds_dwordx4 v5, s[12:13] offset:1024
    v_mfma_f32_32x32x16_bf16 v[160:175], v[20:23], v[64:67], v[160:175]
    global_load_lds_dwordx4 v5, s[12:13] offset:2048
    v_mfma_f32_32x32x16_bf16 v[176:191], v[20:23], v[68:71], v[176:191]
    global_load_lds_dwordx4 v5, s[12:13] offset:3072
    s_add_u32 s12, s12, 16384
    s_addc_u32 s13, s13, 0
    v_mfma_f32_32x32x16_bf16 v[192:207], v[24:27], v[64:67], v[192:207]
    global_load_dwordx4 v[48:51], v4, s[10:11] offset:0
    v_mfma_f32_32x32x16_bf16 v[208:223], v[24:27], v[68:71], v[208:223]
    global_load_dwordx4 v[52:55], v4, s[10:11] offset:2048
    v_mfma_f32_32x32x16_bf16 v[224:239], v[28:31], v[64:67], v[224:239]
    global_load_dwordx4 v[56:59], v4, s[10:11] offset:1024
    v_mfma_f32_32x32x16_bf16 v[240:255], v[28:31], v[68:71], v[240:255]
    global_load_dwordx4 v[60:63], v4, s[10:11] offset:3072
    s_add_u32 s10, s10, 8192
    s_addc_u32 s11, s11, 0
    s_waitcnt vmcnt(24) lgkmcnt(0)
    s_barrier
    ds_read_b128 v[16:19], v7 offset:32768
    ds_read_b128 v[20:23], v7 offset:34816
    ds_read_b128 v[24:27], v7 offset:40960
    ds_read_b128 v[28:31], v7 offset:43008
    v_mfma_f32_32x32x16_bf16 v[128:143], v[32:35], v[72:75], v[128:143]
    v_mfma_f32_32x32x16_bf16 v[144:159], v[32:35], v[76:79], v[144:159]
    v_mfma_f32_32x32x16_bf16 v[160:175], v[36:39], v[72:75], v[160:175]
    v_mfma_f32_32x32x16_bf16 v[176:191], v[36:39], v[76:79], v[176:191]
    v_mfma_f32_32x32x16_bf16 v[192:207], v[40:43], v[72:75], v[192:207]
    v_mfma_f32_32x32x16_bf16 v[208:223], v[40:43], v[76:79], v[208:223]
    v_mfma_f32_32x32x16_bf16 v[224:239], v[44:47], v[72:75], v[224:239]
    v_mfma_f32_32x32x16_bf16 v[240:255], v[44:47], v[76:79], v[240:255]
    ds_read_b128 v[32:35], v7 offset:33792
    ds_read_b128 v[36:39], v7 offset:35840
    ds_read_b128 v[40:43], v7 offset:41984
    ds_read_b128 v[44:47], v7 offset:44032
    s_waitcnt lgkmcnt(4)
    v_mfma_f32_32x32x16_bf16 v[128:143], v[16:19], v[80:83], v[128:143]
    s_add_u32 m0, s15, 16384
    s_nop 0
    global_load_lds_dwordx4 v5, s[12:13]
    v_mfma_f32_32x32x16_bf16 v[144:159], v[16:19], v[84:87], v[144:159]
    global_load_lds_dwordx4 v5, s[12:13] offset:1024
    v_mfma_f32_32x32x16_bf16 v[160:175], v[20:23], v[80:83], v[160:175]
    global_load_lds_dwordx4 v5, s[12:13] offset:2048
    v_mfma_f32_32x32x16_bf16 v[176:191], v[20:23], v[84:87], v[176:191]
    global_load_lds_dwordx4 v5, s[12:13] offset:3072
    s_add_u32 s12, s12, 16384
    s_addc_u32 s13, s13, 0
    v_mfma_f32_32x32x16_bf16 v[192:207], v[24:27], v[80:83], v[192:207]
    global_load_dwordx4 v[64:67], v4, s[10:11] offset:0
    v_mfma_f32_32x32x16_bf16 v[208:223], v[24:27], v[84:87], v[208:223]
    global_load_dwordx4 v[68:71], v4, s[10:11] offset:2048
    v_mfma_f32_32x32x16_bf16 v[224:239], v[28:31], v[80:83], v[224:239]
    global_load_dwordx4 v[72:75], v4, s[10:11] offset:1024
    v_mfma_f32_32x32x16_bf16 v[240:255], v[28:31], v[84:87], v[240:255]
    global_load_dwordx4 v[76:79], v4, s[10:11] offset:3072
    s_add_u32 s10, s10, 8192
    s_addc_u32 s11, s11, 0
    s_waitcnt vmcnt(24) lgkmcnt(0)
    s_barrier
    ds_read_b128 v[16:19], v7 offset:49152
    ds_read_b128 v[20:23], v7 offset:51200
    ds_read_b128 v[24:27], v7 offset:57344
    ds_read_b128 v[28:31], v7 offset:59392
    v_mfma_f32_32x32x16_bf16 v[128:143], v[32:35], v[88:91], v[128:143]
    v_mfma_f32_32x32x16_bf16 v[144:159], v[32:35], v[92:95], v[144:159]
    v_mfma_f32_32x32x16_bf16 v[160:175], v[36:39], v[88:91], v[160:175]
    v_mfma_f32_32x32x16_bf16 v[176:191], v[36:39], v[92:95], v[176:191]
    v_mfma_f32_32x32x16_bf16 v[192:207], v[40:43], v[88:91], v[192:207]
    v_mfma_f32_32x32x16_bf16 v[208:223], v[40:43], v[92:95], v[208:223]
    v_mfma_f32_32x32x16_bf16 v[224:239], v[44:47], v[88:91], v[224:239]
    v_mfma_f32_32x32x16_bf16 v[240:255], v[44:47], v[92:95], v[240:255]
    ds_read_b128 v[32:35], v7 offset:50176
    ds_read_b128 v[36:39], v7 offset:52224
    ds_read_b128 v[40:43], v7 offset:58368
    ds_read_b128 v[44:47], v7 offset:60416
    s_waitcnt lgkmcnt(4)
    v_mfma_f32_32x32x16_bf16 v[128:143], v[16:19], v[96:99], v[128:143]
    s_add_u32 m0, s15, 32768
    s_nop 0
    global_load_lds_dwordx4 v5, s[12:13]
    v_mfma_f32_32x32x16_bf16 v[144:159], v[16:19], v[100:103], v[144:159]
    global_load_lds_dwordx4 v5, s[12:13] offset:1024
    v_mfma_f32_32x32x16_bf16 v[160:175], v[20:23], v[96:99], v[160:175]
    global_load_lds_dwordx4 v5, s[12:13] offset:2048
    v_mfma_f32_32x32x16_bf16 v[176:191], v[20:23], v[100:103], v[176:191]
    global_load_lds_dwordx4 v5, s[12:13] offset:3072
    s_add_u32 s12, s12, 16384
    s_addc_u32 s13, s13, 0
    v_mfma_f32_32x32x16_bf16 v[192:207], v[24:27], v[96:99], v[192:207]
    global_load_dwordx4 v[80:83], v4, s[10:11] offset:0
    v_mfma_f32_32x32x16_bf16 v[208:223], v[24:27], v[100:103], v[208:223]
    global_load_dwordx4 v[84:87], v4, s[10:11] offset:2048
    v_mfma_f32_32x32x16_bf16 v[224:239], v[28:31], v[96:99], v[224:239]
    global_load_dwordx4 v[88:91], v4, s[10:11] offset:1024
    v_mfma_f32_32x32x16_bf16 v[240:255], v[28:31], v[100:103], v[240:255]
    global_load_dwordx4 v[92:95], v4, s[10:11] offset:3072
    s_add_u32 s10, s10, 8192
    s_addc_u32 s11, s11, 0
    s_waitcnt vmcnt(24) lgkmcnt(0)
    s_barrier
    ds_read_b128 v[16:19], v6 offset:0
    ds_read_b128 v[20:23], v6 offset:2048
    ds_read_b128 v[24:27], v6 offset:8192
    ds_read_b128 v[28:31], v6 offset:10240
    v_mfma_f32_32x32x16_bf16 v[128:143], v[32:35], v[104:107], v[128:143]
    v_mfma_f32_32x32x16_bf16 v[144:159], v[32:35], v[108:111], v[144:159]
    v_mfma_f32_32x32x16_bf16 v[160:175], v[36:39], v[104:107], v[160:175]
    v_mfma_f32_32x32x16_bf16 v[176:191], v[36:39], v[108:111], v[176:191]
    v_mfma_f32_32x32x16_bf16 v[192:207], v[40:43], v[104:107], v[192:207]
    v_mfma_f32_32x32x16_bf16 v[208:223], v[40:43], v[108:111], v[208:223]
    v_mfma_f32_32x32x16_bf16 v[224:239], v[44:47], v[104:107], v[224:239]
    v_mfma_f32_32x32x16_bf16 v[240:255], v[44:47], v[108:111], v[240:255]
    ds_read_b128 v[32:35], v6 offset:1024
    ds_read_b128 v[36:39], v6 offset:3072
    ds_read_b128 v[40:43], v6 offset:9216
    ds_read_b128 v[44:47], v6 offset:11264
    s_waitcnt lgkmcnt(4)
    v_mfma_f32_32x32x16_bf16 v[128:143], v[16:19], v[112:115], v[128:143]
    s_add_u32 m0, s15, 49152
    s_nop 0
    global_load_lds_dwordx4 v5, s[12:13]
    v_mfma_f32_32x32x16_bf16 v[144:159], v[16:19], v[116:119], v[144:159]
    global_load_lds_dwordx4 v5, s[12:13] offset:1024
    v_mfma_f32_32x32x16_bf16 v[160:175], v[20:23], v[112:115], v[160:175]
    global_load_lds_dwordx4 v5, s[12:13] offset:2048
    v_mfma_f32_32x32x16_bf16 v[176:191], v[20:23], v[116:119], v[176:191]
    global_load_lds_dwordx4 v5, s[12:13] offset:3072
    s_add_u32 s12, s12, 16384
    s_addc_u32 s13, s13, 0
    v_mfma_f32_32x32x16_bf16 v[192:207], v[24:27], v[112:115], v[192:207]
    global_load_dwordx4 v[96:99], v4, s[10:11] offset:0
    v_mfma_f32_32x32x16_bf16 v[208:223], v[24:27], v[116:119], v[208:223]
    global_load_dwordx4 v[100:103], v4, s[10:11] offset:2048
    v_mfma_f32_32x32x16_bf16 v[224:239], v[28:31], v[112:115], v[224:239]
    global_load_dwordx4 v[104:107], v4, s[10:11] offset:1024
    v_mfma_f32_32x32x16_bf16 v[240:255], v[28:31], v[116:119], v[240:255]
    global_load_dwordx4 v[108:111], v4, s[10:11] offset:3072
    s_add_u32 s10, s10, 8192
    s_addc_u32 s11, s11, 0
    s_waitcnt vmcnt(24) lgkmcnt(0)
    s_barrier
    ds_read_b128 v[16:19], v7 offset:0
    ds_read_b128 v[20:23], v7 offset:2048
    ds_read_b128 v[24:27], v7 offset:8192
    ds_read_b128 v[28:31], v7 offset:10240
    v_mfma_f32_32x32x16_bf16 v[128:143], v[32:35], v[120:123], v[128:143]
    v_mfma_f32_32x32x16_bf16 v[144:159], v[32:35], v[124:127], v[144:159]
    v_mfma_f32_32x32x16_bf16 v[160:175], v[36:39], v[120:123], v[160:175]
    v_mfma_f32_32x32x16_bf16 v[176:191], v[36:39], v[124:127], v[176:191]
    v_mfma_f32_32x32x16_bf16 v[192:207], v[40:43], v[120:123], v[192:207]
    v_mfma_f32_32x32x16_bf16 v[208:223], v[40:43], v[124:127], v[208:223]
    v_mfma_f32_32x32x16_bf16 v[224:239], v[44:47], v[120:123], v[224:239]
    v_mfma_f32_32x32x16_bf16 v[240:255], v[44:47], v[124:127], v[240:255]
    ds_read_b128 v[32:35], v7 offset:1024
    ds_read_b128 v[36:39], v7 offset:3072
    ds_read_b128 v[40:43], v7 offset:9216
    ds_read_b128 v[44:47], v7 offset:11264
    s_waitcnt lgkmcnt(4)
    v_mfma_f32_32x32x16_bf16 v[128:143], v[16:19], v[48:51], v[128:143]
    s_add_u32 m0, s15, 65536
    s_nop 0
    global_load_lds_dwordx4 v5, s[12:13]
    v_mfma_f32_32x32x16_bf16 v[144:159], v[16:19], v[52:55], v[144:159]
    global_load_lds_dwordx4 v5, s[12:13] offset:1024
    v_mfma_f32_32x32x16_bf16 v[160:175], v[20:23], v[48:51], v[160:175]
    global_load_lds_dwordx4 v5, s[12:13] offset:2048
    v_mfma_f32_32x32x16_bf16 v[176:191], v[20:23], v[52:55], v[176:191]
    global_load_lds_dwordx4 v5, s[12:13] offset:3072
    s_add_u32 s12, s12, 16384
    s_addc_u32 s13, s13, 0
    v_mfma_f32_32x32x16_bf16 v[192:207], v[24:27], v[48:51], v[192:207]
    global_load_dwordx4 v[112:115], v4, s[10:11] offset:0
    v_mfma_f32_32x32x16_bf16 v[208:223], v[24:27], v[52:55], v[208:223]
    global_load_dwordx4 v[116:119], v4, s[10:11] offset:2048
    v_mfma_f32_32x32x16_bf16 v[224:239], v[28:31], v[48:51], v[224:239]
    global_load_dwordx4 v[120:123], v4, s[10:11] offset:1024
    v_mfma_f32_32x32x16_bf16 v[240:255], v[28:31], v[52:55], v[240:255]
    global_load_dwordx4 v[124:127], v4, s[10:11] offset:3072
    s_add_u32 s10, s10, 8192
    s_addc_u32 s11, s11, 0
    s_waitcnt vmcnt(24) lgkmcnt(0)
    s_barrier
    ds_read_b128 v[16:19], v7 offset:16384
    ds_read_b128 v[20:23], v7 offset:18432
    ds_read_b128 v[24:27], v7 offset:24576
    ds_read_b128 v[28:31], v7 offset:26624
    v_mfma_f32_32x32x16_bf16 v[128:143], v[32:35], v[56:59], v[128:143]
    v_mfma_f32_32x32x16_bf16 v[144:159], v[32:35], v[60:63], v[144:159]
    v_mfma_f32_32x32x16_bf16 v[160:175], v[36:39], v[56:59], v[160:175]
    v_mfma_f32_32x32x16_bf16 v[176:191], v[36:39], v[60:63], v[176:191]
    v_mfma_f32_32x32x16_bf16 v[192:207], v[40:43], v[56:59], v[192:207]
    v_mfma_f32_32x32x16_bf16 v[208:223], v[40:43], v[60:63], v[208:223]
    v_mfma_f32_32x32x16_bf16 v[224:239], v[44:47], v[56:59], v[224:239]
    v_mfma_f32_32x32x16_bf16 v[240:255], v[44:47], v[60:63], v[240:255]
    ds_read_b128 v[32:35], v7 offset:17408
    ds_read_b128 v[36:39], v7 offset:19456
    ds_read_b128 v[40:43], v7 offset:25600
    ds_read_b128 v[44:47], v7 offset:27648
    s_waitcnt lgkmcnt(4)
    v_mfma_f32_32x32x16_bf16 v[128:143], v[16:19], v[64:67], v[128:143]
    s_add_u32 m0, s15, 0
    s_nop 0
    global_load_lds_dwordx4 v5, s[12:13]
    v_mfma_f32_32x32x16_bf16 v[144:159], v[16:19], v[68:71], v[144:159]
    global_load_lds_dwordx4 v5, s[12:13] offset:1024
    v_mfma_f32_32x32x16_bf16 v[160:175], v[20:23], v[64:67], v[160:175]
    global_load_lds_dwordx4 v5, s[12:13] offset:2048
    v_mfma_f32_32x32x16_bf16 v[176:191], v[20:23], v[68:71], v[176:191]
    global_load_lds_dwordx4 v5, s[12:13] offset:3072
    s_add_u32 s12, s12, 16384
    s_addc_u32 s13, s13, 0
    v_mfma_f32_32x32x16_bf16 v[192:207], v[24:27], v[64:67], v[192:207]
    global_load_dwordx4 v[48:51], v4, s[10:11] offset:0
    v_mfma_f32_32x32x16_bf16 v[208:223], v[24:27], v[68:71], v[208:223]
    global_load_dwordx4 v[52:55], v4, s[10:11] offset:2048
    v_mfma_f32_32x32x16_bf16 v[224:239], v[28:31], v[64:67], v[224:239]
    global_load_dwordx4 v[56:59], v4, s[10:11] offset:1024
    v_mfma_f32_32x32x16_bf16 v[240:255], v[28:31], v[68:71], v[240:255]
    global_load_dwordx4 v[60:63], v4, s[10:11] offset:3072
    s_add_u32 s10, s10, 8192
    s_addc_u32 s11, s11, 0
    s_waitcnt vmcnt(24) lgkmcnt(0)
    s_barrier
    ds_read_b128 v[16:19], v7 offset:32768
    ds_read_b128 v[20:23], v7 offset:34816
    ds_read_b128 v[24:27], v7 offset:40960
    ds_read_b128 v[28:31], v7 offset:43008
    v_mfma_f32_32x32x16_bf16 v[128:143], v[32:35], v[72:75], v[128:143]
    v_mfma_f32_32x32x16_bf16 v[144:159], v[32:35], v[76:79], v[144:159]
    v_mfma_f32_32x32x16_bf16 v[160:175], v[36:39], v[72:75], v[160:175]
    v_mfma_f32_32x32x16_bf16 v[176:191], v[36:39], v[76:79], v[176:191]
    v_mfma_f32_32x32x16_bf16 v[192:207], v[40:43], v[72:75], v[192:207]
    v_mfma_f32_32x32x16_bf16 v[208:223], v[40:43], v[76:79], v[208:223]
    v_mfma_f32_32x32x16_bf16 v[224:239], v[44:47], v[72:75], v[224:239]
    v_mfma_f32_32x32x16_bf16 v[240:255], v[44:47], v[76:79], v[240:255]
    ds_read_b128 v[32:35], v7 offset:33792
    ds_read_b128 v[36:39], v7 offset:35840
    ds_read_b128 v[40:43], v7 offset:41984
    ds_read_b128 v[44:47], v7 offset:44032
    s_waitcnt lgkmcnt(4)
    v_mfma_f32_32x32x16_bf16 v[128:143], v[16:19], v[80:83], v[128:143]
    v_mfma_f32_32x32x16_bf16 v[144:159], v[16:19], v[84:87], v[144:159]
    v_mfma_f32_32x32x16_bf16 v[160:175], v[20:23], v[80:83], v[160:175]
    v_mfma_f32_32x32x16_bf16 v[176:191], v[20:23], v[84:87], v[176:191]
    v_mfma_f32_32x32x16_bf16 v[192:207], v[24:27], v[80:83], v[192:207]
    v_mfma_f32_32x32x16_bf16 v[208:223], v[24:27], v[84:87], v[208:223]
    v_mfma_f32_32x32x16_bf16 v[224:239], v[28:31], v[80:83], v[224:239]
    v_mfma_f32_32x32x16_bf16 v[240:255], v[28:31], v[84:87], v[240:255]
    s_waitcnt vmcnt(16) lgkmcnt(0)
    s_barrier
    ds_read_b128 v[16:19], v7 offset:49152
    ds_read_b128 v[20:23], v7 offset:51200
    ds_read_b128 v[24:27], v7 offset:57344
    ds_read_b128 v[28:31], v7 offset:59392
    v_mfma_f32_32x32x16_bf16 v[128:143], v[32:35], v[88:91], v[128:143]
    global_load_dword v9, v8, s[6:7] sc0 sc1
    v_mfma_f32_32x32x16_bf16 v[144:159], v[32:35], v[92:95], v[144:159]
    v_lshl_add_u32 v4, v1, 4, s29
    v_xor_b32 v5, 0x400, v4
    v_mfma_f32_32x32x16_bf16 v[160:175], v[36:39], v[88:91], v[160:175]
    v_mfma_f32_32x32x16_bf16 v[176:191], v[36:39], v[92:95], v[176:191]
    v_mfma_f32_32x32x16_bf16 v[192:207], v[40:43], v[88:91], v[192:207]
    v_mfma_f32_32x32x16_bf16 v[208:223], v[40:43], v[92:95], v[208:223]
    v_mfma_f32_32x32x16_bf16 v[224:239], v[44:47], v[88:91], v[224:239]
    v_mfma_f32_32x32x16_bf16 v[240:255], v[44:47], v[92:95], v[240:255]
    ds_read_b128 v[32:35], v7 offset:50176
    ds_read_b128 v[36:39], v7 offset:52224
    ds_read_b128 v[40:43], v7 offset:58368
    ds_read_b128 v[44:47], v7 offset:60416
    s_waitcnt lgkmcnt(4)
    v_mfma_f32_32x32x16_bf16 v[128:143], v[16:19], v[96:99], v[128:143]
    v_mfma_f32_32x32x16_bf16 v[144:159], v[16:19], v[100:103], v[144:159]
    v_mfma_f32_32x32x16_bf16 v[160:175], v[20:23], v[96:99], v[160:175]
    v_mfma_f32_32x32x16_bf16 v[176:191], v[20:23], v[100:103], v[176:191]
    v_mfma_f32_32x32x16_bf16 v[192:207], v[24:27], v[96:99], v[192:207]
    v_mfma_f32_32x32x16_bf16 v[208:223], v[24:27], v[100:103], v[208:223]
    v_mfma_f32_32x32x16_bf16 v[224:239], v[28:31], v[96:99], v[224:239]
    v_mfma_f32_32x32x16_bf16 v[240:255], v[28:31], v[100:103], v[240:255]
    s_waitcnt vmcnt(9) lgkmcnt(0)
    s_barrier
    ds_read_b128 v[16:19], v6 offset:0
    ds_read_b128 v[20:23], v6 offset:2048
    ds_read_b128 v[24:27], v6 offset:8192
    ds_read_b128 v[28:31], v6 offset:10240
    v_mfma_f32_32x32x16_bf16 v[128:143], v[32:35], v[104:107], v[128:143]
    v_mfma_f32_32x32x16_bf16 v[144:159], v[32:35], v[108:111], v[144:159]
    v_mfma_f32_32x32x16_bf16 v[160:175], v[36:39], v[104:107], v[160:175]
    v_mfma_f32_32x32x16_bf16 v[176:191], v[36:39], v[108:111], v[176:191]
    v_mfma_f32_32x32x16_bf16 v[192:207], v[40:43], v[104:107], v[192:207]
    v_mfma_f32_32x32x16_bf16 v[208:223], v[40:43], v[108:111], v[208:223]
    v_mfma_f32_32x32x16_bf16 v[224:239], v[44:47], v[104:107], v[224:239]
    v_mfma_f32_32x32x16_bf16 v[240:255], v[44:47], v[108:111], v[240:255]
    ds_read_b128 v[32:35], v6 offset:1024
    ds_read_b128 v[36:39], v6 offset:3072
    ds_read_b128 v[40:43], v6 offset:9216
    ds_read_b128 v[44:47], v6 offset:11264
    s_waitcnt lgkmcnt(4)
    v_mfma_f32_32x32x16_bf16 v[128:143], v[16:19], v[112:115], v[128:143]
    v_mfma_f32_32x32x16_bf16 v[144:159], v[16:19], v[116:119], v[144:159]
    v_mfma_f32_32x32x16_bf16 v[160:175], v[20:23], v[112:115], v[160:175]
    v_mfma_f32_32x32x16_bf16 v[176:191], v[20:23], v[116:119], v[176:191]
    v_mfma_f32_32x32x16_bf16 v[192:207], v[24:27], v[112:115], v[192:207]
    v_mfma_f32_32x32x16_bf16 v[208:223], v[24:27], v[116:119], v[208:223]
    v_mfma_f32_32x32x16_bf16 v[224:239], v[28:31], v[112:115], v[224:239]
    v_mfma_f32_32x32x16_bf16 v[240:255], v[28:31], v[116:119], v[240:255]
    s_waitcnt vmcnt(1) lgkmcnt(0)
    s_barrier
    ds_read_b128 v[16:19], v7 offset:0
    ds_read_b128 v[20:23], v7 offset:2048
    ds_read_b128 v[24:27], v7 offset:8192
    ds_read_b128 v[28:31], v7 offset:10240
    v_mfma_f32_32x32x16_bf16 v[128:143], v[32:35], v[120:123], v[128:143]
    v_mfma_f32_32x32x16_bf16 v[144:159], v[32:35], v[124:127], v[144:159]
    v_mfma_f32_32x32x16_bf16 v[160:175], v[36:39], v[120:123], v[160:175]
    v_mfma_f32_32x32x16_bf16 v[176:191], v[36:39], v[124:127], v[176:191]
    v_mfma_f32_32x32x16_bf16 v[192:207], v[40:43], v[120:123], v[192:207]
    v_mfma_f32_32x32x16_bf16 v[208:223], v[40:43], v[124:127], v[208:223]
    v_mfma_f32_32x32x16_bf16 v[224:239], v[44:47], v[120:123], v[224:239]
    v_mfma_f32_32x32x16_bf16 v[240:255], v[44:47], v[124:127], v[240:255]
    ds_read_b128 v[32:35], v7 offset:1024
    ds_read_b128 v[36:39], v7 offset:3072
    ds_read_b128 v[40:43], v7 offset:9216
    ds_read_b128 v[44:47], v7 offset:11264
    s_waitcnt lgkmcnt(4)
    v_mfma_f32_32x32x16_bf16 v[128:143], v[16:19], v[48:51], v[128:143]
    v_mfma_f32_32x32x16_bf16 v[144:159], v[16:19], v[52:55], v[144:159]
    v_mfma_f32_32x32x16_bf16 v[160:175], v[20:23], v[48:51], v[160:175]
    v_mfma_f32_32x32x16_bf16 v[176:191], v[20:23], v[52:55], v[176:191]
    v_mfma_f32_32x32x16_bf16 v[192:207], v[24:27], v[48:51], v[192:207]
    v_mfma_f32_32x32x16_bf16 v[208:223], v[24:27], v[52:55], v[208:223]
    v_mfma_f32_32x32x16_bf16 v[224:239], v[28:31], v[48:51], v[224:239]
    v_mfma_f32_32x32x16_bf16 v[240:255], v[28:31], v[52:55], v[240:255]
    s_waitcnt lgkmcnt(0)
    s_barrier
    v_mfma_f32_32x32x16_bf16 v[128:143], v[32:35], v[56:59], v[128:143]
    v_mfma_f32_32x32x16_bf16 v[144:159], v[32:35], v[60:63], v[144:159]
    s_waitcnt vmcnt(0)
    v_cmp_ne_u32 vcc, 1, v9
    s_cbranch_vccnz L_pf_slow
L_pf_ok:
    v_mfma_f32_32x32x16_bf16 v[160:175], v[36:39], v[56:59], v[160:175]
    global_load_dwordx4 v[64:67], v4, s[30:31] offset:0
    v_mfma_f32_32x32x16_bf16 v[176:191], v[36:39], v[60:63], v[176:191]
    global_load_dwordx4 v[68:71], v5, s[30:31] offset:0
    v_mfma_f32_32x32x16_bf16 v[192:207], v[40:43], v[56:59], v[192:207]
    global_load_dwordx4 v[72:75], v4, s[30:31] offset:2048
    v_mfma_f32_32x32x16_bf16 v[208:223], v[40:43], v[60:63], v[208:223]
    global_load_dwordx4 v[76:79], v5, s[30:31] offset:2048
    s_add_u32 s30, s30, 4096
    s_addc_u32 s31, s31, 0
    v_mfma_f32_32x32x16_bf16 v[224:239], v[44:47], v[56:59], v[224:239]
    global_load_dwordx4 v[80:83], v4, s[30:31] offset:0
    v_mfma_f32_32x32x16_bf16 v[240:255], v[44:47], v[60:63], v[240:255]
    global_load_dwordx4 v[84:87], v5, s[30:31] offset:0
    v_mov_b32 v8, 0xc0135761
    v_mov_b32 v9, 0xc0135761
    v_mov_b32 v10, 0xbdd2d3e8
    v_mov_b32 v11, 0xbdd2d3e8
    v_mov_b32 v12, 1.0
    v_mov_b32 v13, 1.0
    s_lshl_b32 s16, s4, 1
    s_and_b32 s17, s3, 1
    s_add_u32 s16, s16, s17
    s_mul_i32 s16, s16, 229376
    s_lshl_b32 s17, s5, 3
    s_lshr_b32 s18, s3, 1
    s_lshl_b32 s18, s18, 2
    s_add_u32 s17, s17, s18
    s_lshl_b32 s17, s17, 11
    s_add_u32 s16, s16, s17
    s_add_u32 s16, s16, 0xc00000
    v_add_u32 v14, s16, v3
    v_add_u32 v15, 0x1000, v14
    v_cvt_pk_bf16_f32 v18, v128, v129
    v_cvt_pk_bf16_f32 v26, v130, v131
    v_cvt_pk_bf16_f32 v34, v132, v133
    v_cvt_pk_bf16_f32 v42, v134, v135
    v_cvt_pk_bf16_f32 v23, v192, v193
    v_cvt_pk_bf16_f32 v31, v194, v195
    v_cvt_pk_bf16_f32 v39, v196, v197
    v_cvt_pk_bf16_f32 v47, v198, v199
    v_lshlrev_b32 v16, 16, v18
    v_lshlrev_b32 v24, 16, v26
    global_load_dwordx4 v[88:91], v4, s[30:31] offset:2048
    v_lshlrev_b32 v32, 16, v34
    v_lshlrev_b32 v40, 16, v42
    v_and_b32 v17, 0xffff0000, v18
    v_and_b32 v25, 0xffff0000, v26
    v_and_b32 v33, 0xffff0000, v34
    v_and_b32 v41, 0xffff0000, v42
    v_pk_mul_f32 v[18:19], v[16:17], v[16:17]
    v_pk_mul_f32 v[26:27], v[24:25], v[24:25]
    v_pk_mul_f32 v[34:35], v[32:33], v[32:33]
    v_pk_mul_f32 v[42:43], v[40:41], v[40:41]
    global_load_dwordx4 v[92:95], v5, s[30:31] offset:2048
    s_add_u32 s30, s30, 4096
    s_addc_u32 s31, s31, 0
    v_pk_fma_f32 v[18:19], v[18:19], v[10:11], v[8:9]
    v_pk_fma_f32 v[26:27], v[26:27], v[10:11], v[8:9]
    v_pk_fma_f32 v[34:35], v[34:35], v[10:11], v[8:9]
    v_pk_fma_f32 v[42:43], v[42:43], v[10:11], v[8:9]
    v_pk_mul_f32 v[18:19], v[18:19], v[16:17]
    v_pk_mul_f32 v[26:27], v[26:27], v[24:25]
    v_pk_mul_f32 v[34:35], v[34:35], v[32:33]
    v_pk_mul_f32 v[42:43], v[42:43], v[40:41]
    v_exp_f32 v20, v18
    v_exp_f32 v28, v26
    global_load_dwordx4 v[96:99], v4, s[30:31] offset:0
    v_exp_f32 v36, v34
    v_exp_f32 v44, v42
    v_exp_f32 v21, v19
    v_exp_f32 v29, v27
    v_exp_f32 v37, v35
    v_exp_f32 v45, v43
    v_lshlrev_b32 v22, 16, v23
    v_lshlrev_b32 v30, 16, v31
    v_lshlrev_b32 v38, 16, v39
    v_lshlrev_b32 v46, 16, v47
    global_load_dwordx4 v[100:103], v5, s[30:31] offset:0
    v_and_b32 v23, 0xffff0000, v23
    v_and_b32 v31, 0xffff0000, v31
    v_and_b32 v39, 0xffff0000, v39
    v_and_b32 v47, 0xffff0000, v47
    v_pk_add_f32 v[20:21], v[20:21], v[12:13]
    v_pk_add_f32 v[28:29], v[28:29], v[12:13]
    v_pk_add_f32 v[36:37], v[36:37], v[12:13]
    v_pk_add_f32 v[44:45], v[44:45], v[12:13]
    v_rcp_f32 v20, v20
    v_rcp_f32 v28, v28
    global_load_dwordx4 v[104:107], v4, s[30:31] offset:2048
    v_rcp_f32 v36, v36
    v_rcp_f32 v44, v44
    v_rcp_f32 v21, v21
    v_rcp_f32 v29, v29
    v_rcp_f32 v37, v37
    v_rcp_f32 v45, v45
    v_pk_mul_f32 v[18:19], v[16:17], v[20:21]
    v_pk_mul_f32 v[26:27], v[24:25], v[28:29]
    v_pk_mul_f32 v[34:35], v[32:33], v[36:37]
    v_pk_mul_f32 v[42:43], v[40:41], v[44:45]
    global_load_dwordx4 v[108:111], v5, s[30:31] offset:2048
    s_add_u32 s30, s30, 4096
    s_addc_u32 s31, s31, 0
    v_cvt_pk_bf16_f32 v20, v18, v19
    v_cvt_pk_bf16_f32 v28, v26, v27
    v_cvt_pk_bf16_f32 v36, v34, v35
    v_cvt_pk_bf16_f32 v44, v42, v43
    v_lshlrev_b32 v18, 16, v20
    v_lshlrev_b32 v26, 16, v28
    v_lshlrev_b32 v34, 16, v36
    v_lshlrev_b32 v42, 16, v44
    v_and_b32 v19, 0xffff0000, v20
    v_and_b32 v27, 0xffff0000, v28
    global_load_dwordx4 v[112:115], v4, s[30:31] offset:0
    v_and_b32 v35, 0xffff0000, v36
    v_and_b32 v43, 0xffff0000, v44
    v_pk_mul_f32 v[18:19], v[18:19], v[22:23]
    v_pk_mul_f32 v[26:27], v[26:27], v[30:31]
    v_pk_mul_f32 v[34:35], v[34:35], v[38:39]
    v_pk_mul_f32 v[42:43], v[42:43], v[46:47]
    v_cvt_pk_bf16_f32 v48, v18, v19
    v_cvt_pk_bf16_f32 v49, v26, v27
    v_cvt_pk_bf16_f32 v50, v34, v35
    v_cvt_pk_bf16_f32 v51, v42, v43
    global_load_dwordx4 v[116:119], v5, s[30:31] offset:0
    global_store_dwordx4 v14, v[48:51], s[6:7] offset:0 sc0 sc1
    v_cvt_pk_bf16_f32 v18, v136, v137
    v_cvt_pk_bf16_f32 v26, v138, v139
    v_cvt_pk_bf16_f32 v34, v140, v141
    v_cvt_pk_bf16_f32 v42, v142, v143
    v_cvt_pk_bf16_f32 v23, v200, v201
    v_cvt_pk_bf16_f32 v31, v202, v203
    v_cvt_pk_bf16_f32 v39, v204, v205
    v_cvt_pk_bf16_f32 v47, v206, v207
    v_lshlrev_b32 v16, 16, v18
    v_lshlrev_b32 v24, 16, v26
    global_load_dwordx4 v[120:123], v4, s[30:31] offset:2048
    v_lshlrev_b32 v32, 16, v34
    v_lshlrev_b32 v40, 16, v42
    v_and_b32 v17, 0xffff0000, v18
    v_and_b32 v25, 0xffff0000, v26
    v_and_b32 v33, 0xffff0000, v34
    v_and_b32 v41, 0xffff0000, v42
    v_pk_mul_f32 v[18:19], v[16:17], v[16:17]
    v_pk_mul_f32 v[26:27], v[24:25], v[24:25]
    v_pk_mul_f32 v[34:35], v[32:33], v[32:33]
    v_pk_mul_f32 v[42:43], v[40:41], v[40:41]
    global_load_dwordx4 v[124:127], v5, s[30:31] offset:2048
    s_add_u32 s30, s30, 4096
    s_addc_u32 s31, s31, 0
    v_pk_fma_f32 v[18:19], v[18:19], v[10:11], v[8:9]
    v_pk_fma_f32 v[26:27], v[26:27], v[10:11], v[8:9]
    v_pk_fma_f32 v[34:35], v[34:35], v[10:11], v[8:9]
    v_pk_fma_f32 v[42:43], v[42:43], v[10:11], v[8:9]
    v_pk_mul_f32 v[18:19], v[18:19], v[16:17]
    v_pk_mul_f32 v[26:27], v[26:27], v[24:25]
    v_pk_mul_f32 v[34:35], v[34:35], v[32:33]
    v_pk_mul_f32 v[42:43], v[42:43], v[40:41]
    v_exp_f32 v20, v18
    v_exp_f32 v28, v26
    s_add_u32 m0, s28, 0
    s_nop 0
    global_load_lds_dwordx4 v3, s[26:27] offset:0
    v_exp_f32 v36, v34
    v_exp_f32 v44, v42
    v_exp_f32 v21, v19
    v_exp_f32 v29, v27
    v_exp_f32 v37, v35
    v_exp_f32 v45, v43
    v_lshlrev_b32 v22, 16, v23
    v_lshlrev_b32 v30, 16, v31
    v_lshlrev_b32 v38, 16, v39
    v_lshlrev_b32 v46, 16, v47
    global_load_lds_dwordx4 v3, s[26:27] offset:1024
    v_and_b32 v23, 0xffff0000, v23
    v_and_b32 v31, 0xffff0000, v31
    v_and_b32 v39, 0xffff0000, v39
    v_and_b32 v47, 0xffff0000, v47
    v_pk_add_f32 v[20:21], v[20:21], v[12:13]
    v_pk_add_f32 v[28:29], v[28:29], v[12:13]
    v_pk_add_f32 v[36:37], v[36:37], v[12:13]
    v_pk_add_f32 v[44:45], v[44:45], v[12:13]
    v_rcp_f32 v20, v20
    v_rcp_f32 v28, v28
    global_load_lds_dwordx4 v3, s[26:27] offset:2048
    v_rcp_f32 v36, v36
    v_rcp_f32 v44, v44
    v_rcp_f32 v21, v21
    v_rcp_f32 v29, v29
    v_rcp_f32 v37, v37
    v_rcp_f32 v45, v45
    v_pk_mul_f32 v[18:19], v[16:17], v[20:21]
    v_pk_mul_f32 v[26:27], v[24:25], v[28:29]
    v_pk_mul_f32 v[34:35], v[32:33], v[36:37]
    v_pk_mul_f32 v[42:43], v[40:41], v[44:45]
    global_load_lds_dwordx4 v3, s[26:27] offset:3072
    s_add_u32 s26, s26, 4096
    s_addc_u32 s27, s27, 0
    v_cvt_pk_bf16_f32 v20, v18, v19
    v_cvt_pk_bf16_f32 v28, v26, v27
    v_cvt_pk_bf16_f32 v36, v34, v35
    v_cvt_pk_bf16_f32 v44, v42, v43
    v_lshlrev_b32 v18, 16, v20
    v_lshlrev_b32 v26, 16, v28
    v_lshlrev_b32 v34, 16, v36
    v_lshlrev_b32 v42, 16, v44
    v_and_b32 v19, 0xffff0000, v20
    v_and_b32 v27, 0xffff0000, v28
    s_add_u32 m0, s28, 4096
    s_nop 0
    global_load_lds_dwordx4 v3, s[26:27] offset:0
    v_and_b32 v35, 0xffff0000, v36
    v_and_b32 v43, 0xffff0000, v44
    v_pk_mul_f32 v[18:19], v[18:19], v[22:23]
    v_pk_mul_f32 v[26:27], v[26:27], v[30:31]
    v_pk_mul_f32 v[34:35], v[34:35], v[38:39]
    v_pk_mul_f32 v[42:43], v[42:43], v[46:47]
    v_cvt_pk_bf16_f32 v52, v18, v19
    v_cvt_pk_bf16_f32 v53, v26, v27
    v_cvt_pk_bf16_f32 v54, v34, v35
    v_cvt_pk_bf16_f32 v55, v42, v43
    global_load_lds_dwordx4 v3, s[26:27] offset:1024
    global_store_dwordx4 v14, v[52:55], s[6:7] offset:2048 sc0 sc1
    v_cvt_pk_bf16_f32 v18, v144, v145
    v_cvt_pk_bf16_f32 v26, v146, v147
    v_cvt_pk_bf16_f32 v34, v148, v149
    v_cvt_pk_bf16_f32 v42, v150, v151
    v_cvt_pk_bf16_f32 v23, v208, v209
    v_cvt_pk_bf16_f32 v31, v210, v211
    v_cvt_pk_bf16_f32 v39, v212, v213
    v_cvt_pk_bf16_f32 v47, v214, v215
    v_lshlrev_b32 v16, 16, v18
    v_lshlrev_b32 v24, 16, v26
    global_load_lds_dwordx4 v3, s[26:27] offset:2048
    v_lshlrev_b32 v32, 16, v34
    v_lshlrev_b32 v40, 16, v42
    v_and_b32 v17, 0xffff0000, v18
    v_and_b32 v25, 0xffff0000, v26
    v_and_b32 v33, 0xffff0000, v34
    v_and_b32 v41, 0xffff0000, v42
    v_pk_mul_f32 v[18:19], v[16:17], v[16:17]
    v_pk_mul_f32 v[26:27], v[24:25], v[24:25]
    v_pk_mul_f32 v[34:35], v[32:33], v[32:33]
    v_pk_mul_f32 v[42:43], v[40:41], v[40:41]
    global_load_lds_dwordx4 v3, s[26:27] offset:3072
    s_add_u32 s26, s26, 4096
    s_addc_u32 s27, s27, 0
    v_pk_fma_f32 v[18:19], v[18:19], v[10:11], v[8:9]
    v_pk_fma_f32 v[26:27], v[26:27], v[10:11], v[8:9]
    v_pk_fma_f32 v[34:35], v[34:35], v[10:11], v[8:9]
    v_pk_fma_f32 v[42:43], v[42:43], v[10:11], v[8:9]
    v_pk_mul_f32 v[18:19], v[18:19], v[16:17]
    v_pk_mul_f32 v[26:27], v[26:27], v[24:25]
    v_pk_mul_f32 v[34:35], v[34:35], v[32:33]
    v_pk_mul_f32 v[42:43], v[42:43], v[40:41]
    v_exp_f32 v20, v18
    v_exp_f32 v28, v26
    s_add_u32 m0, s28, 8192
    s_nop 0
    global_load_lds_dwordx4 v3, s[26:27] offset:0
    v_exp_f32 v36, v34
    v_exp_f32 v44, v42
    v_exp_f32 v21, v19
    v_exp_f32 v29, v27
    v_exp_f32 v37, v35
    v_exp_f32 v45, v43
    v_lshlrev_b32 v22, 16, v23
    v_lshlrev_b32 v30, 16, v31
    v_lshlrev_b32 v38, 16, v39
    v_lshlrev_b32 v46, 16, v47
    global_load_lds_dwordx4 v3, s[26:27] offset:1024
    v_and_b32 v23, 0xffff0000, v23
    v_and_b32 v31, 0xffff0000, v31
    v_and_b32 v39, 0xffff0000, v39
    v_and_b32 v47, 0xffff0000, v47
    v_pk_add_f32 v[20:21], v[20:21], v[12:13]
    v_pk_add_f32 v[28:29], v[28:29], v[12:13]
    v_pk_add_f32 v[36:37], v[36:37], v[12:13]
    v_pk_add_f32 v[44:45], v[44:45], v[12:13]
    v_rcp_f32 v20, v20
    v_rcp_f32 v28, v28
    global_load_lds_dwordx4 v3, s[26:27] offset:2048
    v_rcp_f32 v36, v36
    v_rcp_f32 v44, v44
    v_rcp_f32 v21, v21
    v_rcp_f32 v29, v29
    v_rcp_f32 v37, v37
    v_rcp_f32 v45, v45
    v_pk_mul_f32 v[18:19], v[16:17], v[20:21]
    v_pk_mul_f32 v[26:27], v[24:25], v[28:29]
    v_pk_mul_f32 v[34:35], v[32:33], v[36:37]
    v_pk_mul_f32 v[42:43], v[40:41], v[44:45]
    global_load_lds_dwordx4 v3, s[26:27] offset:3072
    s_add_u32 s26, s26, 4096
    s_addc_u32 s27, s27, 0
    v_cvt_pk_bf16_f32 v20, v18, v19
    v_cvt_pk_bf16_f32 v28, v26, v27
    v_cvt_pk_bf16_f32 v36, v34, v35
    v_cvt_pk_bf16_f32 v44, v42, v43
    v_lshlrev_b32 v18, 16, v20
    v_lshlrev_b32 v26, 16, v28
    v_lshlrev_b32 v34, 16, v36
    v_lshlrev_b32 v42, 16, v44
    v_and_b32 v19, 0xffff0000, v20
    v_and_b32 v27, 0xffff0000, v28
    s_add_u32 m0, s28, 12288
    s_nop 0
    global_load_lds_dwordx4 v3, s[26:27] offset:0
    v_and_b32 v35, 0xffff0000, v36
    v_and_b32 v43, 0xffff0000, v44
    v_pk_mul_f32 v[18:19], v[18:19], v[22:23]
    v_pk_mul_f32 v[26:27], v[26:27], v[30:31]
    v_pk_mul_f32 v[34:35], v[34:35], v[38:39]
    v_pk_mul_f32 v[42:43], v[42:43], v[46:47]
    v_cvt_pk_bf16_f32 v56, v18, v19
    v_cvt_pk_bf16_f32 v57, v26, v27
    v_cvt_pk_bf16_f32 v58, v34, v35
    v_cvt_pk_bf16_f32 v59, v42, v43
    global_load_lds_dwordx4 v3, s[26:27] offset:1024
    global_store_dwordx4 v14, v[56:59], s[6:7] offset:1024 sc0 sc1
    v_cvt_pk_bf16_f32 v18, v152, v153
    v_cvt_pk_bf16_f32 v26, v154, v155
    v_cvt_pk_bf16_f32 v34, v156, v157
    v_cvt_pk_bf16_f32 v42, v158, v159
    v_cvt_pk_bf16_f32 v23, v216, v217
    v_cvt_pk_bf16_f32 v31, v218, v219
    v_cvt_pk_bf16_f32 v39, v220, v221
    v_cvt_pk_bf16_f32 v47, v222, v223
    v_lshlrev_b32 v16, 16, v18
    v_lshlrev_b32 v24, 16, v26
    global_load_lds_dwordx4 v3, s[26:27] offset:2048
    v_lshlrev_b32 v32, 16, v34
    v_lshlrev_b32 v40, 16, v42
    v_and_b32 v17, 0xffff0000, v18
    v_and_b32 v25, 0xffff0000, v26
    v_and_b32 v33, 0xffff0000, v34
    v_and_b32 v41, 0xffff0000, v42
    v_pk_mul_f32 v[18:19], v[16:17], v[16:17]
    v_pk_mul_f32 v[26:27], v[24:25], v[24:25]
    v_pk_mul_f32 v[34:35], v[32:33], v[32:33]
    v_pk_mul_f32 v[42:43], v[40:41], v[40:41]
    global_load_lds_dwordx4 v3, s[26:27] offset:3072
    s_add_u32 s26, s26, 4096
    s_addc_u32 s27, s27, 0
    v_pk_fma_f32 v[18:19], v[18:19], v[10:11], v[8:9]
    v_pk_fma_f32 v[26:27], v[26:27], v[10:11], v[8:9]
    v_pk_fma_f32 v[34:35], v[34:35], v[10:11], v[8:9]
    v_pk_fma_f32 v[42:43], v[42:43], v[10:11], v[8:9]
    v_pk_mul_f32 v[18:19], v[18:19], v[16:17]
    v_pk_mul_f32 v[26:27], v[26:27], v[24:25]
    v_pk_mul_f32 v[34:35], v[34:35], v[32:33]
    v_pk_mul_f32 v[42:43], v[42:43], v[40:41]
    v_exp_f32 v20, v18
    v_exp_f32 v28, v26
    s_add_u32 m0, s28, 16384
    s_nop 0
    global_load_lds_dwordx4 v3, s[26:27] offset:0
    v_exp_f32 v36, v34
    v_exp_f32 v44, v42
    v_exp_f32 v21, v19
    v_exp_f32 v29, v27
    v_exp_f32 v37, v35
    v_exp_f32 v45, v43
    v_lshlrev_b32 v22, 16, v23
    v_lshlrev_b32 v30, 16, v31
    v_lshlrev_b32 v38, 16, v39
    v_lshlrev_b32 v46, 16, v47
    global_load_lds_dwordx4 v3, s[26:27] offset:1024
    v_and_b32 v23, 0xffff0000, v23
    v_and_b32 v31, 0xffff0000, v31
    v_and_b32 v39, 0xffff0000, v39
    v_and_b32 v47, 0xffff0000, v47
    v_pk_add_f32 v[20:21], v[20:21], v[12:13]
    v_pk_add_f32 v[28:29], v[28:29], v[12:13]
    v_pk_add_f32 v[36:37], v[36:37], v[12:13]
    v_pk_add_f32 v[44:45], v[44:45], v[12:13]
    v_rcp_f32 v20, v20
    v_rcp_f32 v28, v28
    global_load_lds_dwordx4 v3, s[26:27] offset:2048
    v_rcp_f32 v36, v36
    v_rcp_f32 v44, v44
    v_rcp_f32 v21, v21
    v_rcp_f32 v29, v29
    v_rcp_f32 v37, v37
    v_rcp_f32 v45, v45
    v_pk_mul_f32 v[18:19], v[16:17], v[20:21]
    v_pk_mul_f32 v[26:27], v[24:25], v[28:29]
    v_pk_mul_f32 v[34:35], v[32:33], v[36:37]
    v_pk_mul_f32 v[42:43], v[40:41], v[44:45]
    global_load_lds_dwordx4 v3, s[26:27] offset:3072
    s_add_u32 s26, s26, 4096
    s_addc_u32 s27, s27, 0
    v_cvt_pk_bf16_f32 v20, v18, v19
    v_cvt_pk_bf16_f32 v28, v26, v27
    v_cvt_pk_bf16_f32 v36, v34, v35
    v_cvt_pk_bf16_f32 v44, v42, v43
    v_lshlrev_b32 v18, 16, v20
    v_lshlrev_b32 v26, 16, v28
    v_lshlrev_b32 v34, 16, v36
    v_lshlrev_b32 v42, 16, v44
    v_and_b32 v19, 0xffff0000, v20
    v_and_b32 v27, 0xffff0000, v28
    v_and_b32 v35, 0xffff0000, v36
    v_and_b32 v43, 0xffff0000, v44
    v_pk_mul_f32 v[18:19], v[18:19], v[22:23]
    v_pk_mul_f32 v[26:27], v[26:27], v[30:31]
    v_pk_mul_f32 v[34:35], v[34:35], v[38:39]
    v_pk_mul_f32 v[42:43], v[42:43], v[46:47]
    v_cvt_pk_bf16_f32 v60, v18, v19
    v_cvt_pk_bf16_f32 v61, v26, v27
    v_cvt_pk_bf16_f32 v62, v34, v35
    v_cvt_pk_bf16_f32 v63, v42, v43
    global_store_dwordx4 v14, v[60:63], s[6:7] offset:3072 sc0 sc1
    v_cvt_pk_bf16_f32 v18, v160, v161
    v_cvt_pk_bf16_f32 v26, v162, v163
    v_cvt_pk_bf16_f32 v34, v164, v165
    v_cvt_pk_bf16_f32 v42, v166, v167
    v_cvt_pk_bf16_f32 v23, v224, v225
    v_cvt_pk_bf16_f32 v31, v226, v227
    v_cvt_pk_bf16_f32 v39, v228, v229
    v_cvt_pk_bf16_f32 v47, v230, v231
    v_lshlrev_b32 v16, 16, v18
    v_lshlrev_b32 v24, 16, v26
    v_lshlrev_b32 v32, 16, v34
    v_lshlrev_b32 v40, 16, v42
    v_and_b32 v17, 0xffff0000, v18
    v_and_b32 v25, 0xffff0000, v26
    v_and_b32 v33, 0xffff0000, v34
    v_and_b32 v41, 0xffff0000, v42
    v_pk_mul_f32 v[18:19], v[16:17], v[16:17]
    v_pk_mul_f32 v[26:27], v[24:25], v[24:25]
    v_pk_mul_f32 v[34:35], v[32:33], v[32:33]
    v_pk_mul_f32 v[42:43], v[40:41], v[40:41]
    v_pk_fma_f32 v[18:19], v[18:19], v[10:11], v[8:9]
    v_pk_fma_f32 v[26:27], v[26:27], v[10:11], v[8:9]
    v_pk_fma_f32 v[34:35], v[34:35], v[10:11], v[8:9]
    v_pk_fma_f32 v[42:43], v[42:43], v[10:11], v[8:9]
    v_pk_mul_f32 v[18:19], v[18:19], v[16:17]
    v_pk_mul_f32 v[26:27], v[26:27], v[24:25]
    v_pk_mul_f32 v[34:35], v[34:35], v[32:33]
    v_pk_mul_f32 v[42:43], v[42:43], v[40:41]
    v_exp_f32 v20, v18
    v_exp_f32 v28, v26
    v_exp_f32 v36, v34
    v_exp_f32 v44, v42
    v_exp_f32 v21, v19
    v_exp_f32 v29, v27
    v_exp_f32 v37, v35
    v_exp_f32 v45, v43
    v_lshlrev_b32 v22, 16, v23
    v_lshlrev_b32 v30, 16, v31
    v_lshlrev_b32 v38, 16, v39
    v_lshlrev_b32 v46, 16, v47
    v_and_b32 v23, 0xffff0000, v23
    v_and_b32 v31, 0xffff0000, v31
    v_and_b32 v39, 0xffff0000, v39
    v_and_b32 v47, 0xffff0000, v47
    v_pk_add_f32 v[20:21], v[20:21], v[12:13]
    v_pk_add_f32 v[28:29], v[28:29], v[12:13]
    v_pk_add_f32 v[36:37], v[36:37], v[12:13]
    v_pk_add_f32 v[44:45], v[44:45], v[12:13]
    v_rcp_f32 v20, v20
    v_rcp_f32 v28, v28
    v_rcp_f32 v36, v36
    v_rcp_f32 v44, v44
    v_rcp_f32 v21, v21
    v_rcp_f32 v29, v29
    v_rcp_f32 v37, v37
    v_rcp_f32 v45, v45
    v_pk_mul_f32 v[18:19], v[16:17], v[20:21]
    v_pk_mul_f32 v[26:27], v[24:25], v[28:29]
    v_pk_mul_f32 v[34:35], v[32:33], v[36:37]
    v_pk_mul_f32 v[42:43], v[40:41], v[44:45]
    v_cvt_pk_bf16_f32 v20, v18, v19
    v_cvt_pk_bf16_f32 v28, v26, v27
    v_cvt_pk_bf16_f32 v36, v34, v35
    v_cvt_pk_bf16_f32 v44, v42, v43
    v_lshlrev_b32 v18, 16, v20
    v_lshlrev_b32 v26, 16, v28
    v_lshlrev_b32 v34, 16, v36
    v_lshlrev_b32 v42, 16, v44
    v_and_b32 v19, 0xffff0000, v20
    v_and_b32 v27, 0xffff0000, v28
    v_and_b32 v35, 0xffff0000, v36
    v_and_b32 v43, 0xffff0000, v44
    v_pk_mul_f32 v[18:19], v[18:19], v[22:23]
    v_pk_mul_f32 v[26:27], v[26:27], v[30:31]
    v_pk_mul_f32 v[34:35], v[34:35], v[38:39]
    v_pk_mul_f32 v[42:43], v[42:43], v[46:47]
    v_cvt_pk_bf16_f32 v48, v18, v19
    v_cvt_pk_bf16_f32 v49, v26, v27
    v_cvt_pk_bf16_f32 v50, v34, v35
    v_cvt_pk_bf16_f32 v51, v42, v43
    global_store_dwordx4 v15, v[48:51], s[6:7] offset:0 sc0 sc1
    v_cvt_pk_bf16_f32 v18, v168, v169
    v_cvt_pk_bf16_f32 v26, v170, v171
    v_cvt_pk_bf16_f32 v34, v172, v173
    v_cvt_pk_bf16_f32 v42, v174, v175
    v_cvt_pk_bf16_f32 v23, v232, v233
    v_cvt_pk_bf16_f32 v31, v234, v235
    v_cvt_pk_bf16_f32 v39, v236, v237
    v_cvt_pk_bf16_f32 v47, v238, v239
    v_lshlrev_b32 v16, 16, v18
    v_lshlrev_b32 v24, 16, v26
    v_lshlrev_b32 v32, 16, v34
    v_lshlrev_b32 v40, 16, v42
    v_and_b32 v17, 0xffff0000, v18
    v_and_b32 v25, 0xffff0000, v26
    v_and_b32 v33, 0xffff0000, v34
    v_and_b32 v41, 0xffff0000, v42
    v_pk_mul_f32 v[18:19], v[16:17], v[16:17]
    v_pk_mul_f32 v[26:27], v[24:25], v[24:25]
    v_pk_mul_f32 v[34:35], v[32:33], v[32:33]
    v_pk_mul_f32 v[42:43], v[40:41], v[40:41]
    v_pk_fma_f32 v[18:19], v[18:19], v[10:11], v[8:9]
    v_pk_fma_f32 v[26:27], v[26:27], v[10:11], v[8:9]
    v_pk_fma_f32 v[34:35], v[34:35], v[10:11], v[8:9]
    v_pk_fma_f32 v[42:43], v[42:43], v[10:11], v[8:9]
    v_pk_mul_f32 v[18:19], v[18:19], v[16:17]
    v_pk_mul_f32 v[26:27], v[26:27], v[24:25]
    v_pk_mul_f32 v[34:35], v[34:35], v[32:33]
    v_pk_mul_f32 v[42:43], v[42:43], v[40:41]
    v_exp_f32 v20, v18
    v_exp_f32 v28, v26
    v_exp_f32 v36, v34
    v_exp_f32 v44, v42
    v_exp_f32 v21, v19
    v_exp_f32 v29, v27
    v_exp_f32 v37, v35
    v_exp_f32 v45, v43
    v_lshlrev_b32 v22, 16, v23
    v_lshlrev_b32 v30, 16, v31
    v_lshlrev_b32 v38, 16, v39
    v_lshlrev_b32 v46, 16, v47
    v_and_b32 v23, 0xffff0000, v23
    v_and_b32 v31, 0xffff0000, v31
    v_and_b32 v39, 0xffff0000, v39
    v_and_b32 v47, 0xffff0000, v47
    v_pk_add_f32 v[20:21], v[20:21], v[12:13]
    v_pk_add_f32 v[28:29], v[28:29], v[12:13]
    v_pk_add_f32 v[36:37], v[36:37], v[12:13]
    v_pk_add_f32 v[44:45], v[44:45], v[12:13]
    v_rcp_f32 v20, v20
    v_rcp_f32 v28, v28
    v_rcp_f32 v36, v36
    v_rcp_f32 v44, v44
    v_rcp_f32 v21, v21
    v_rcp_f32 v29, v29
    v_rcp_f32 v37, v37
    v_rcp_f32 v45, v45
    v_pk_mul_f32 v[18:19], v[16:17], v[20:21]
    v_pk_mul_f32 v[26:27], v[24:25], v[28:29]
    v_pk_mul_f32 v[34:35], v[32:33], v[36:37]
    v_pk_mul_f32 v[42:43], v[40:41], v[44:45]
    v_cvt_pk_bf16_f32 v20, v18, v19
    v_cvt_pk_bf16_f32 v28, v26, v27
    v_cvt_pk_bf16_f32 v36, v34, v35
    v_cvt_pk_bf16_f32 v44, v42, v43
    v_lshlrev_b32 v18, 16, v20
    v_lshlrev_b32 v26, 16, v28
    v_lshlrev_b32 v34, 16, v36
    v_lshlrev_b32 v42, 16, v44
    v_and_b32 v19, 0xffff0000, v20
    v_and_b32 v27, 0xffff0000, v28
    v_and_b32 v35, 0xffff0000, v36
    v_and_b32 v43, 0xffff0000, v44
    v_pk_mul_f32 v[18:19], v[18:19], v[22:23]
    v_pk_mul_f32 v[26:27], v[26:27], v[30:31]
    v_pk_mul_f32 v[34:35], v[34:35], v[38:39]
    v_pk_mul_f32 v[42:43], v[42:43], v[46:47]
    v_cvt_pk_bf16_f32 v52, v18, v19
    v_cvt_pk_bf16_f32 v53, v26, v27
    v_cvt_pk_bf16_f32 v54, v34, v35
    v_cvt_pk_bf16_f32 v55, v42, v43
    global_store_dwordx4 v15, v[52:55], s[6:7] offset:2048 sc0 sc1
    v_cvt_pk_bf16_f32 v18, v176, v177
    v_cvt_pk_bf16_f32 v26, v178, v179
    v_cvt_pk_bf16_f32 v34, v180, v181
    v_cvt_pk_bf16_f32 v42, v182, v183
    v_cvt_pk_bf16_f32 v23, v240, v241
    v_cvt_pk_bf16_f32 v31, v242, v243
    v_cvt_pk_bf16_f32 v39, v244, v245
    v_cvt_pk_bf16_f32 v47, v246, v247
    v_lshlrev_b32 v16, 16, v18
    v_lshlrev_b32 v24, 16, v26
    v_lshlrev_b32 v32, 16, v34
    v_lshlrev_b32 v40, 16, v42
    v_and_b32 v17, 0xffff0000, v18
    v_and_b32 v25, 0xffff0000, v26
    v_and_b32 v33, 0xffff0000, v34
    v_and_b32 v41, 0xffff0000, v42
    v_pk_mul_f32 v[18:19], v[16:17], v[16:17]
    v_pk_mul_f32 v[26:27], v[24:25], v[24:25]
    v_pk_mul_f32 v[34:35], v[32:33], v[32:33]
    v_pk_mul_f32 v[42:43], v[40:41], v[40:41]
    v_pk_fma_f32 v[18:19], v[18:19], v[10:11], v[8:9]
    v_pk_fma_f32 v[26:27], v[26:27], v[10:11], v[8:9]
    v_pk_fma_f32 v[34:35], v[34:35], v[10:11], v[8:9]
    v_pk_fma_f32 v[42:43], v[42:43], v[10:11], v[8:9]
    v_pk_mul_f32 v[18:19], v[18:19], v[16:17]
    v_pk_mul_f32 v[26:27], v[26:27], v[24:25]
    v_pk_mul_f32 v[34:35], v[34:35], v[32:33]
    v_pk_mul_f32 v[42:43], v[42:43], v[40:41]
    v_exp_f32 v20, v18
    v_exp_f32 v28, v26
    v_exp_f32 v36, v34
    v_exp_f32 v44, v42
    v_exp_f32 v21, v19
    v_exp_f32 v29, v27
    v_exp_f32 v37, v35
    v_exp_f32 v45, v43
    v_lshlrev_b32 v22, 16, v23
    v_lshlrev_b32 v30, 16, v31
    v_lshlrev_b32 v38, 16, v39
    v_lshlrev_b32 v46, 16, v47
    v_and_b32 v23, 0xffff0000, v23
    v_and_b32 v31, 0xffff0000, v31
    v_and_b32 v39, 0xffff0000, v39
    v_and_b32 v47, 0xffff0000, v47
    v_pk_add_f32 v[20:21], v[20:21], v[12:13]
    v_pk_add_f32 v[28:29], v[28:29], v[12:13]
    v_pk_add_f32 v[36:37], v[36:37], v[12:13]
    v_pk_add_f32 v[44:45], v[44:45], v[12:13]
    v_rcp_f32 v20, v20
    v_rcp_f32 v28, v28
    v_rcp_f32 v36, v36
    v_rcp_f32 v44, v44
    v_rcp_f32 v21, v21
    v_rcp_f32 v29, v29
    v_rcp_f32 v37, v37
    v_rcp_f32 v45, v45
    v_pk_mul_f32 v[18:19], v[16:17], v[20:21]
    v_pk_mul_f32 v[26:27], v[24:25], v[28:29]
    v_pk_mul_f32 v[34:35], v[32:33], v[36:37]
    v_pk_mul_f32 v[42:43], v[40:41], v[44:45]
    v_cvt_pk_bf16_f32 v20, v18, v19
    v_cvt_pk_bf16_f32 v28, v26, v27
    v_cvt_pk_bf16_f32 v36, v34, v35
    v_cvt_pk_bf16_f32 v44, v42, v43
    v_lshlrev_b32 v18, 16, v20
    v_lshlrev_b32 v26, 16, v28
    v_lshlrev_b32 v34, 16, v36
    v_lshlrev_b32 v42, 16, v44
    v_and_b32 v19, 0xffff0000, v20
    v_and_b32 v27, 0xffff0000, v28
    v_and_b32 v35, 0xffff0000, v36
    v_and_b32 v43, 0xffff0000, v44
    v_pk_mul_f32 v[18:19], v[18:19], v[22:23]
    v_pk_mul_f32 v[26:27], v[26:27], v[30:31]
    v_pk_mul_f32 v[34:35], v[34:35], v[38:39]
    v_pk_mul_f32 v[42:43], v[42:43], v[46:47]
    v_cvt_pk_bf16_f32 v56, v18, v19
    v_cvt_pk_bf16_f32 v57, v26, v27
    v_cvt_pk_bf16_f32 v58, v34, v35
    v_cvt_pk_bf16_f32 v59, v42, v43
    global_store_dwordx4 v15, v[56:59], s[6:7] offset:1024 sc0 sc1
    v_cvt_pk_bf16_f32 v18, v184, v185
    v_cvt_pk_bf16_f32 v26, v186, v187
    v_cvt_pk_bf16_f32 v34, v188, v189
    v_cvt_pk_bf16_f32 v42, v190, v191
    v_cvt_pk_bf16_f32 v23, v248, v249
    v_cvt_pk_bf16_f32 v31, v250, v251
    v_cvt_pk_bf16_f32 v39, v252, v253
    v_cvt_pk_bf16_f32 v47, v254, v255
    v_lshlrev_b32 v16, 16, v18
    v_lshlrev_b32 v24, 16, v26
    v_lshlrev_b32 v32, 16, v34
    v_lshlrev_b32 v40, 16, v42
    v_and_b32 v17, 0xffff0000, v18
    v_and_b32 v25, 0xffff0000, v26
    v_and_b32 v33, 0xffff0000, v34
    v_and_b32 v41, 0xffff0000, v42
    v_pk_mul_f32 v[18:19], v[16:17], v[16:17]
    v_pk_mul_f32 v[26:27], v[24:25], v[24:25]
    v_pk_mul_f32 v[34:35], v[32:33], v[32:33]
    v_pk_mul_f32 v[42:43], v[40:41], v[40:41]
    v_pk_fma_f32 v[18:19], v[18:19], v[10:11], v[8:9]
    v_pk_fma_f32 v[26:27], v[26:27], v[10:11], v[8:9]
    v_pk_fma_f32 v[34:35], v[34:35], v[10:11], v[8:9]
    v_pk_fma_f32 v[42:43], v[42:43], v[10:11], v[8:9]
    v_pk_mul_f32 v[18:19], v[18:19], v[16:17]
    v_pk_mul_f32 v[26:27], v[26:27], v[24:25]
    v_pk_mul_f32 v[34:35], v[34:35], v[32:33]
    v_pk_mul_f32 v[42:43], v[42:43], v[40:41]
    v_exp_f32 v20, v18
    v_exp_f32 v28, v26
    v_exp_f32 v36, v34
    v_exp_f32 v44, v42
    v_exp_f32 v21, v19
    v_exp_f32 v29, v27
    v_exp_f32 v37, v35
    v_exp_f32 v45, v43
    v_lshlrev_b32 v22, 16, v23
    v_lshlrev_b32 v30, 16, v31
    v_lshlrev_b32 v38, 16, v39
    v_lshlrev_b32 v46, 16, v47
    v_and_b32 v23, 0xffff0000, v23
    v_and_b32 v31, 0xffff0000, v31
    v_and_b32 v39, 0xffff0000, v39
    v_and_b32 v47, 0xffff0000, v47
    v_pk_add_f32 v[20:21], v[20:21], v[12:13]
    v_pk_add_f32 v[28:29], v[28:29], v[12:13]
    v_pk_add_f32 v[36:37], v[36:37], v[12:13]
    v_pk_add_f32 v[44:45], v[44:45], v[12:13]
    v_rcp_f32 v20, v20
    v_rcp_f32 v28, v28
    v_rcp_f32 v36, v36
    v_rcp_f32 v44, v44
    v_rcp_f32 v21, v21
    v_rcp_f32 v29, v29
    v_rcp_f32 v37, v37
    v_rcp_f32 v45, v45
    v_pk_mul_f32 v[18:19], v[16:17], v[20:21]
    v_pk_mul_f32 v[26:27], v[24:25], v[28:29]
    v_pk_mul_f32 v[34:35], v[32:33], v[36:37]
    v_pk_mul_f32 v[42:43], v[40:41], v[44:45]
    v_cvt_pk_bf16_f32 v20, v18, v19
    v_cvt_pk_bf16_f32 v28, v26, v27
    v_cvt_pk_bf16_f32 v36, v34, v35
    v_cvt_pk_bf16_f32 v44, v42, v43
    v_lshlrev_b32 v18, 16, v20
    v_lshlrev_b32 v26, 16, v28
    v_lshlrev_b32 v34, 16, v36
    v_lshlrev_b32 v42, 16, v44
    v_and_b32 v19, 0xffff0000, v20
    v_and_b32 v27, 0xffff0000, v28
    v_and_b32 v35, 0xffff0000, v36
    v_and_b32 v43, 0xffff0000, v44
    v_pk_mul_f32 v[18:19], v[18:19], v[22:23]
    v_pk_mul_f32 v[26:27], v[26:27], v[30:31]
    v_pk_mul_f32 v[34:35], v[34:35], v[38:39]
    v_pk_mul_f32 v[42:43], v[42:43], v[46:47]
    v_cvt_pk_bf16_f32 v60, v18, v19
    v_cvt_pk_bf16_f32 v61, v26, v27
    v_cvt_pk_bf16_f32 v62, v34, v35
    v_cvt_pk_bf16_f32 v63, v42, v43
    global_store_dwordx4 v15, v[60:63], s[6:7] offset:3072 sc0 sc1
    s_waitcnt vmcnt(0)
    s_barrier
    s_cmp_lg_u32 s14, 0
    s_cbranch_scc1 L_G2
    s_lshl_b32 s8, s4, 4
    s_add_u32 s8, s8, s5
    s_lshl_b32 s8, s8, 2
    s_add_u32 s8, s8, 0x2000800
    v_mov_b32 v3, s8
    v_mov_b32 v4, 1
    global_store_dword v3, v4, s[6:7] sc0 sc1
L_G2:
    s_load_dwordx2 s[4:5], s[0:1], 0
    s_load_dwordx2 s[8:9], s[0:1], 88
    s_mov_b32 s3, s14
    s_lshr_b32 s10, s2, 5
    s_and_b32 s11, s2, 7
    s_lshl_b32 s11, s11, 1
    s_bfe_u32 s12, s2, 0x10003
    s_or_b32 s11, s11, s12
    s_and_b32 s12, s2, 16
    s_or_b32 s11, s11, s12
    s_lshr_b32 s12, s3, 1
    s_and_b32 s13, s3, 1
    v_min_u32 v12, 13, v1
    s_lshr_b32 s17, s11, 1
    s_lshl_b32 s17, s17, 4
    v_add_u32 v12, s17, v12
    v_lshlrev_b32 v12, 2, v12
    v_add_u32 v12, 0x2000800, v12
    global_load_dword v14, v12, s[6:7] sc0 sc1
    s_mul_i32 s14, s3, 28
    s_mul_i32 s15, s11, 112
    s_add_u32 s15, s15, s14
    s_lshl_b32 s15, s15, 11
    s_add_u32 s15, s15, 0xc01000
    s_add_u32 s20, s6, s15
    s_addc_u32 s21, s7, 0
    v_lshlrev_b32 v3, 4, v1
    v_add_u32 v4, s29, v3
    v_xor_b32 v5, 0x400, v4
    s_lshl_b32 s17, s13, 10
    v_add_u32 v6, s17, v3
    v_xor_b32 v7, 0x400, v6
    v_and_b32 v8, 31, v1
    s_lshl_b32 s17, s11, 6
    s_lshl_b32 s18, s13, 5
    s_add_u32 s17, s17, s18
    v_add_u32 v8, s17, v8
    v_lshrrev_b32 v9, 5, v1
    v_lshlrev_b32 v9, 4, v9
    s_lshl_b32 s17, s10, 6
    s_lshl_b32 s18, s12, 5
    s_add_u32 s17, s17, s18
    v_add_u32 v9, s17, v9
    v_lshlrev_b32 v10, 10, v8
    v_lshl_add_u32 v10, v9, 1, v10
    v_lshlrev_b32 v11, 12, v9
    v_lshl_add_u32 v11, v8, 1, v11
    v_add_u32 v11, 0xa00000, v11
    v_add_u32 v8, s28, v4
    v_add_u32 v9, s28, v5
    v_and_b32 v13, 31, v1
    s_lshl_b32 s17, s10, 5
    v_add_u32 v13, s17, v13
    v_lshlrev_b32 v13, 2, v13
    v_add_u32 v13, 0x2000c00, v13
    s_add_u32 s26, s26, 4096
    s_addc_u32 s27, s27, 0
    s_waitcnt vmcnt(0) lgkmcnt(0)
    v_cmp_ne_u32 vcc, 1, v14
    s_cbranch_vccz L_G2_poll_ok
    s_mov_b32 s96, 0
L_G2_poll:
    global_load_dword v14, v12, s[6:7] sc0 sc1
    s_waitcnt vmcnt(0)
    v_cmp_ne_u32 vcc, 1, v14
    s_cbranch_vccz L_G2_poll_ok
    s_add_u32 s96, s96, 1
    s_cmp_lt_u32 s96, 131072
    s_cbranch_scc0 L_G2_poll_ok
    s_sleep 2
    s_branch L_G2_poll
L_G2_poll_ok:
    global_load_dwordx4 v[16:19], v6, s[20:21] offset:-4096
    global_load_dwordx4 v[20:23], v7, s[20:21] offset:-4096
    global_load_dwordx4 v[24:27], v6, s[20:21] offset:-2048
    global_load_dwordx4 v[28:31], v7, s[20:21] offset:-2048
    global_load_dwordx4 v[32:35], v6, s[20:21] offset:0
    global_load_dwordx4 v[36:39], v7, s[20:21] offset:0
    global_load_dwordx4 v[40:43], v6, s[20:21] offset:2048
    global_load_dwordx4 v[44:47], v7, s[20:21] offset:2048
    s_add_u32 s20, s20, 8192
    s_addc_u32 s21, s21, 0
    global_load_dwordx4 v[48:51], v6, s[20:21] offset:-4096
    global_load_dwordx4 v[52:55], v7, s[20:21] offset:-4096
    global_load_dwordx4 v[56:59], v6, s[20:21] offset:-2048
    global_load_dwordx4 v[60:63], v7, s[20:21] offset:-2048
    global_load_dwordx4 v[128:131], v6, s[20:21] offset:0
    global_load_dwordx4 v[132:135], v7, s[20:21] offset:0
    global_load_dwordx4 v[136:139], v6, s[20:21] offset:2048
    global_load_dwordx4 v[140:143], v7, s[20:21] offset:2048
    s_add_u32 s20, s20, 8192
    s_addc_u32 s21, s21, 0
    global_load_dwordx4 v[144:147], v6, s[20:21] offset:-4096
    global_load_dwordx4 v[148:151], v7, s[20:21] offset:-4096
    global_load_dwordx4 v[152:155], v6, s[20:21] offset:-2048
    global_load_dwordx4 v[156:159], v7, s[20:21] offset:-2048
    global_load_dwordx4 v[192:195], v6, s[20:21] offset:0
    global_load_dwordx4 v[196:199], v7, s[20:21] offset:0
    global_load_dwordx4 v[200:203], v6, s[20:21] offset:2048
    global_load_dwordx4 v[204:207], v7, s[20:21] offset:2048
    s_add_u32 s20, s20, 8192
    s_addc_u32 s21, s21, 0
    global_load_dwordx4 v[208:211], v6, s[20:21] offset:-4096
    global_load_dwordx4 v[212:215], v7, s[20:21] offset:-4096
    global_load_dwordx4 v[216:219], v6, s[20:21] offset:-2048
    global_load_dwordx4 v[220:223], v7, s[20:21] offset:-2048
    s_waitcnt vmcnt(26)
    v_mfma_f32_32x32x16_bf16 v[160:175], v[64:67], v[16:19], 0
    v_mfma_f32_32x32x16_bf16 v[176:191], v[64:67], v[20:23], 0
    v_mfma_f32_32x32x16_bf16 v[224:239], v[68:71], v[16:19], 0
    v_mfma_f32_32x32x16_bf16 v[240:255], v[68:71], v[20:23], 0
    s_waitcnt vmcnt(24)
    v_mfma_f32_32x32x16_bf16 v[160:175], v[72:75], v[24:27], v[160:175]
    global_load_dwordx4 v[16:19], v6, s[20:21] offset:0
    v_mfma_f32_32x32x16_bf16 v[176:191], v[72:75], v[28:31], v[176:191]
    global_load_dwordx4 v[20:23], v7, s[20:21] offset:0
    v_mfma_f32_32x32x16_bf16 v[224:239], v[76:79], v[24:27], v[224:239]
    v_mfma_f32_32x32x16_bf16 v[240:255], v[76:79], v[28:31], v[240:255]
    s_waitcnt vmcnt(24)
    v_mfma_f32_32x32x16_bf16 v[160:175], v[80:83], v[32:35], v[160:175]
    global_load_dwordx4 v[24:27], v6, s[20:21] offset:2048
    v_mfma_f32_32x32x16_bf16 v[176:191], v[80:83], v[36:39], v[176:191]
    global_load_dwordx4 v[28:31], v7, s[20:21] offset:2048
    v_mfma_f32_32x32x16_bf16 v[224:239], v[84:87], v[32:35], v[224:239]
    v_mfma_f32_32x32x16_bf16 v[240:255], v[84:87], v[36:39], v[240:255]
    s_waitcnt vmcnt(24)
    v_mfma_f32_32x32x16_bf16 v[160:175], v[88:91], v[40:43], v[160:175]
    s_add_u32 s20, s20, 8192
    s_addc_u32 s21, s21, 0
    global_load_dwordx4 v[32:35], v6, s[20:21] offset:-4096
    v_mfma_f32_32x32x16_bf16 v[176:191], v[88:91], v[44:47], v[176:191]
    global_load_dwordx4 v[36:39], v7, s[20:21] offset:-4096
    v_mfma_f32_32x32x16_bf16 v[224:239], v[92:95], v[40:43], v[224:239]
    global_load_dwordx4 v[64:67], v10, s[4:5]
    v_mfma_f32_32x32x16_bf16 v[240:255], v[92:95], v[44:47], v[240:255]
    global_load_dwordx4 v[68:71], v10, s[4:5] offset:16
    s_waitcnt vmcnt(26)
    v_mfma_f32_32x32x16_bf16 v[160:175], v[96:99], v[48:51], v[160:175]
    global_load_dwordx4 v[40:43], v6, s[20:21] offset:-2048
    v_mfma_f32_32x32x16_bf16 v[176:191], v[96:99], v[52:55], v[176:191]
    global_load_dwordx4 v[44:47], v7, s[20:21] offset:-2048
    v_mfma_f32_32x32x16_bf16 v[224:239], v[100:103], v[48:51], v[224:239]
    global_load_dwordx4 v[88:91], v4, s[26:27] offset:-4096
    v_mfma_f32_32x32x16_bf16 v[240:255], v[100:103], v[52:55], v[240:255]
    global_load_dwordx4 v[92:95], v5, s[26:27] offset:-4096
    s_waitcnt vmcnt(28)
    v_mfma_f32_32x32x16_bf16 v[160:175], v[104:107], v[56:59], v[160:175]
    global_load_dwordx4 v[48:51], v6, s[20:21] offset:0
    v_mfma_f32_32x32x16_bf16 v[176:191], v[104:107], v[60:63], v[176:191]
    global_load_dwordx4 v[52:55], v7, s[20:21] offset:0
    v_mfma_f32_32x32x16_bf16 v[224:239], v[108:111], v[56:59], v[224:239]
    global_load_dwordx4 v[96:99], v4, s[26:27] offset:-2048
    v_mfma_f32_32x32x16_bf16 v[240:255], v[108:111], v[60:63], v[240:255]
    global_load_dwordx4 v[100:103], v5, s[26:27] offset:-2048
    s_waitcnt vmcnt(30)
    v_mfma_f32_32x32x16_bf16 v[160:175], v[112:115], v[128:131], v[160:175]
    ds_read_b128 v[56:59], v8 offset:0
    ds_read_b128 v[60:63], v9 offset:0
    v_mfma_f32_32x32x16_bf16 v[176:191], v[112:115], v[132:135], v[176:191]
    global_load_dwordx4 v[104:107], v6, s[20:21] offset:2048
    v_mfma_f32_32x32x16_bf16 v[224:239], v[116:119], v[128:131], v[224:239]
    global_load_dwordx4 v[108:111], v7, s[20:21] offset:2048
    v_mfma_f32_32x32x16_bf16 v[240:255], v[116:119], v[132:135], v[240:255]
    s_waitcnt vmcnt(30)
    v_mfma_f32_32x32x16_bf16 v[160:175], v[120:123], v[136:139], v[160:175]
    ds_read_b128 v[128:131], v8 offset:2048
    ds_read_b128 v[132:135], v9 offset:2048
    v_mfma_f32_32x32x16_bf16 v[176:191], v[120:123], v[140:143], v[176:191]
    global_load_dwordx4 v[112:115], v4, s[26:27] offset:0
    v_mfma_f32_32x32x16_bf16 v[224:239], v[124:127], v[136:139], v[224:239]
    global_load_dwordx4 v[116:119], v5, s[26:27] offset:0
    v_mfma_f32_32x32x16_bf16 v[240:255], v[124:127], v[140:143], v[240:255]
    s_waitcnt vmcnt(30) lgkmcnt(2)
    v_mfma_f32_32x32x16_bf16 v[160:175], v[56:59], v[144:147], v[160:175]
    ds_read_b128 v[136:139], v8 offset:4096
    ds_read_b128 v[140:143], v9 offset:4096
    v_mfma_f32_32x32x16_bf16 v[176:191], v[56:59], v[148:151], v[176:191]
    s_add_u32 s20, s20, 8192
    s_addc_u32 s21, s21, 0
    global_load_dwordx4 v[120:123], v6, s[20:21] offset:-4096
    v_mfma_f32_32x32x16_bf16 v[224:239], v[60:63], v[144:147], v[224:239]
    global_load_dwordx4 v[124:127], v7, s[20:21] offset:-4096
    v_mfma_f32_32x32x16_bf16 v[240:255], v[60:63], v[148:151], v[240:255]
    s_waitcnt vmcnt(30) lgkmcnt(2)
    v_mfma_f32_32x32x16_bf16 v[160:175], v[128:131], v[152:155], v[160:175]
    ds_read_b128 v[144:147], v8 offset:6144
    ds_read_b128 v[148:151], v9 offset:6144
    v_mfma_f32_32x32x16_bf16 v[176:191], v[128:131], v[156:159], v[176:191]
    global_load_dwordx4 v[56:59], v4, s[26:27] offset:2048
    v_mfma_f32_32x32x16_bf16 v[224:239], v[132:135], v[152:155], v[224:239]
    global_load_dwordx4 v[60:63], v5, s[26:27] offset:2048
    v_mfma_f32_32x32x16_bf16 v[240:255], v[132:135], v[156:159], v[240:255]
    s_waitcnt vmcnt(30) lgkmcnt(2)
    v_mfma_f32_32x32x16_bf16 v[160:175], v[136:139], v[192:195], v[160:175]
    ds_read_b128 v[152:155], v8 offset:8192
    ds_read_b128 v[156:159], v9 offset:8192
    v_mfma_f32_32x32x16_bf16 v[176:191], v[136:139], v[196:199], v[176:191]
    global_load_dwordx4 v[128:131], v6, s[20:21] offset:-2048
    v_mfma_f32_32x32x16_bf16 v[224:239], v[140:143], v[192:195], v[224:239]
    global_load_dwordx4 v[132:135], v7, s[20:21] offset:-2048
    v_mfma_f32_32x32x16_bf16 v[240:255], v[140:143], v[196:199], v[240:255]
    s_waitcnt vmcnt(30) lgkmcnt(2)
    v_mfma_f32_32x32x16_bf16 v[160:175], v[144:147], v[200:203], v[160:175]
    ds_read_b128 v[192:195], v8 offset:10240
    ds_read_b128 v[196:199], v9 offset:10240
    v_mfma_f32_32x32x16_bf16 v[176:191], v[144:147], v[204:207], v[176:191]
    s_add_u32 s26, s26, 8192
    s_addc_u32 s27, s27, 0
    global_load_dwordx4 v[136:139], v4, s[26:27] offset:-4096
    v_mfma_f32_32x32x16_bf16 v[224:239], v[148:151], v[200:203], v[224:239]
    global_load_dwordx4 v[140:143], v5, s[26:27] offset:-4096
    v_mfma_f32_32x32x16_bf16 v[240:255], v[148:151], v[204:207], v[240:255]
    s_waitcnt vmcnt(30) lgkmcnt(2)
    v_mfma_f32_32x32x16_bf16 v[160:175], v[152:155], v[208:211], v[160:175]
    ds_read_b128 v[200:203], v8 offset:12288
    ds_read_b128 v[204:207], v9 offset:12288
    v_mfma_f32_32x32x16_bf16 v[176:191], v[152:155], v[212:215], v[176:191]
    global_load_dwordx4 v[144:147], v6, s[20:21] offset:0
    v_mfma_f32_32x32x16_bf16 v[224:239], v[156:159], v[208:211], v[224:239]
    global_load_dwordx4 v[148:151], v7, s[20:21] offset:0
    v_mfma_f32_32x32x16_bf16 v[240:255], v[156:159], v[212:215], v[240:255]
    global_load_dword v14, v13, s[6:7] sc0 sc1
    s_waitcnt vmcnt(31) lgkmcnt(2)
    v_mfma_f32_32x32x16_bf16 v[160:175], v[192:195], v[216:219], v[160:175]
    ds_read_b128 v[208:211], v8 offset:14336
    ds_read_b128 v[212:215], v9 offset:14336
    v_mfma_f32_32x32x16_bf16 v[176:191], v[192:195], v[220:223], v[176:191]
    global_load_dwordx4 v[152:155], v4, s[26:27] offset:-2048
    v_mfma_f32_32x32x16_bf16 v[224:239], v[196:199], v[216:219], v[224:239]
    global_load_dwordx4 v[156:159], v5, s[26:27] offset:-2048
    v_mfma_f32_32x32x16_bf16 v[240:255], v[196:199], v[220:223], v[240:255]
    s_waitcnt vmcnt(31) lgkmcnt(2)
    v_mfma_f32_32x32x16_bf16 v[160:175], v[200:203], v[16:19], v[160:175]
    ds_read_b128 v[216:219], v8 offset:16384
    ds_read_b128 v[220:223], v9 offset:16384
    v_mfma_f32_32x32x16_bf16 v[176:191], v[200:203], v[20:23], v[176:191]
    global_load_dwordx4 v[192:195], v6, s[20:21] offset:2048
    v_mfma_f32_32x32x16_bf16 v[224:239], v[204:207], v[16:19], v[224:239]
    global_load_dwordx4 v[196:199], v7, s[20:21] offset:2048
    v_mfma_f32_32x32x16_bf16 v[240:255], v[204:207], v[20:23], v[240:255]
    s_waitcnt vmcnt(31) lgkmcnt(2)
    v_mfma_f32_32x32x16_bf16 v[160:175], v[208:211], v[24:27], v[160:175]
    ds_read_b128 v[16:19], v8 offset:18432
    ds_read_b128 v[20:23], v9 offset:18432
    v_mfma_f32_32x32x16_bf16 v[176:191], v[208:211], v[28:31], v[176:191]
    global_load_dwordx4 v[200:203], v4, s[26:27] offset:0
    v_mfma_f32_32x32x16_bf16 v[224:239], v[212:215], v[24:27], v[224:239]
    global_load_dwordx4 v[204:207], v5, s[26:27] offset:0
    v_mfma_f32_32x32x16_bf16 v[240:255], v[212:215], v[28:31], v[240:255]
    s_waitcnt vmcnt(31) lgkmcnt(2)
    v_mfma_f32_32x32x16_bf16 v[160:175], v[216:219], v[32:35], v[160:175]
    s_add_u32 s20, s20, 8192
    s_addc_u32 s21, s21, 0
    global_load_dwordx4 v[24:27], v6, s[20:21] offset:-4096
    v_mfma_f32_32x32x16_bf16 v[176:191], v[216:219], v[36:39], v[176:191]
    global_load_dwordx4 v[28:31], v7, s[20:21] offset:-4096
    v_mfma_f32_32x32x16_bf16 v[224:239], v[220:223], v[32:35], v[224:239]
    global_load_dwordx4 v[208:211], v4, s[26:27] offset:2048
    v_mfma_f32_32x32x16_bf16 v[240:255], v[220:223], v[36:39], v[240:255]
    global_load_dwordx4 v[212:215], v5, s[26:27] offset:2048
    s_waitcnt vmcnt(31) lgkmcnt(0)
    v_mfma_f32_32x32x16_bf16 v[160:175], v[16:19], v[40:43], v[160:175]
    global_load_dwordx4 v[32:35], v6, s[20:21] offset:-2048
    v_mfma_f32_32x32x16_bf16 v[176:191], v[16:19], v[44:47], v[176:191]
    global_load_dwordx4 v[36:39], v7, s[20:21] offset:-2048
    v_mfma_f32_32x32x16_bf16 v[224:239], v[20:23], v[40:43], v[224:239]
    s_add_u32 s26, s26, 8192
    s_addc_u32 s27, s27, 0
    global_load_dwordx4 v[216:219], v4, s[26:27] offset:-4096
    v_mfma_f32_32x32x16_bf16 v[240:255], v[20:23], v[44:47], v[240:255]
    global_load_dwordx4 v[220:223], v5, s[26:27] offset:-4096
    s_waitcnt vmcnt(31)
    v_mfma_f32_32x32x16_bf16 v[160:175], v[88:91], v[48:51], v[160:175]
    global_load_dwordx4 v[40:43], v6, s[20:21] offset:0
    v_mfma_f32_32x32x16_bf16 v[176:191], v[88:91], v[52:55], v[176:191]
    global_load_dwordx4 v[44:47], v7, s[20:21] offset:0
    v_mfma_f32_32x32x16_bf16 v[224:239], v[92:95], v[48:51], v[224:239]
    global_load_dwordx4 v[16:19], v4, s[26:27] offset:-2048
    v_mfma_f32_32x32x16_bf16 v[240:255], v[92:95], v[52:55], v[240:255]
    global_load_dwordx4 v[20:23], v5, s[26:27] offset:-2048
    s_waitcnt vmcnt(31)
    v_mfma_f32_32x32x16_bf16 v[160:175], v[96:99], v[104:107], v[160:175]
    global_load_dwordx4 v[48:51], v6, s[20:21] offset:2048
    v_mfma_f32_32x32x16_bf16 v[176:191], v[96:99], v[108:111], v[176:191]
    global_load_dwordx4 v[52:55], v7, s[20:21] offset:2048
    v_mfma_f32_32x32x16_bf16 v[224:239], v[100:103], v[104:107], v[224:239]
    v_mfma_f32_32x32x16_bf16 v[240:255], v[100:103], v[108:111], v[240:255]
    s_waitcnt vmcnt(29)
    v_mfma_f32_32x32x16_bf16 v[160:175], v[112:115], v[120:123], v[160:175]
    v_mfma_f32_32x32x16_bf16 v[176:191], v[112:115], v[124:127], v[176:191]
    v_mfma_f32_32x32x16_bf16 v[224:239], v[116:119], v[120:123], v[224:239]
    v_mfma_f32_32x32x16_bf16 v[240:255], v[116:119], v[124:127], v[240:255]
    s_waitcnt vmcnt(20)
    v_cmp_ne_u32 vcc, 1, v14
    s_cbranch_vccnz L_G2_tb
    global_load_ushort v72, v11, s[6:7]
    v_add_u32 v11, 0x1000, v11
    global_load_ushort v73, v11, s[6:7]
    v_add_u32 v11, 0x1000, v11
    global_load_ushort v74, v11, s[6:7]
    v_add_u32 v11, 0x1000, v11
    global_load_ushort v75, v11, s[6:7]
    v_add_u32 v11, 0x1000, v11
    global_load_ushort v76, v11, s[6:7]
    v_add_u32 v11, 0x1000, v11
    global_load_ushort v77, v11, s[6:7]
    v_add_u32 v11, 0x1000, v11
    global_load_ushort v78, v11, s[6:7]
    v_add_u32 v11, 0x1000, v11
    global_load_ushort v79, v11, s[6:7]
    v_add_u32 v11, 0x1000, v11
    global_load_ushort v80, v11, s[6:7]
    v_add_u32 v11, 0x1000, v11
    global_load_ushort v81, v11, s[6:7]
    v_add_u32 v11, 0x1000, v11
    global_load_ushort v82, v11, s[6:7]
    v_add_u32 v11, 0x1000, v11
    global_load_ushort v83, v11, s[6:7]
    v_add_u32 v11, 0x1000, v11
    global_load_ushort v84, v11, s[6:7]
    v_add_u32 v11, 0x1000, v11
    global_load_ushort v85, v11, s[6:7]
    v_add_u32 v11, 0x1000, v11
    global_load_ushort v86, v11, s[6:7]
    v_add_u32 v11, 0x1000, v11
    global_load_ushort v87, v11, s[6:7]
    v_mfma_f32_32x32x16_bf16 v[160:175], v[56:59], v[128:131], v[160:175]
    v_mfma_f32_32x32x16_bf16 v[176:191], v[56:59], v[132:135], v[176:191]
    v_mfma_f32_32x32x16_bf16 v[224:239], v[60:63], v[128:131], v[224:239]
    v_mfma_f32_32x32x16_bf16 v[240:255], v[60:63], v[132:135], v[240:255]
    v_mfma_f32_32x32x16_bf16 v[160:175], v[136:139], v[144:147], v[160:175]
    v_mfma_f32_32x32x16_bf16 v[176:191], v[136:139], v[148:151], v[176:191]
    v_mfma_f32_32x32x16_bf16 v[224:239], v[140:143], v[144:147], v[224:239]
    v_mfma_f32_32x32x16_bf16 v[240:255], v[140:143], v[148:151], v[240:255]
    s_waitcnt vmcnt(32)
    v_mfma_f32_32x32x16_bf16 v[160:175], v[152:155], v[192:195], v[160:175]
    v_mfma_f32_32x32x16_bf16 v[176:191], v[152:155], v[196:199], v[176:191]
    v_mfma_f32_32x32x16_bf16 v[224:239], v[156:159], v[192:195], v[224:239]
    v_mfma_f32_32x32x16_bf16 v[240:255], v[156:159], v[196:199], v[240:255]
    s_waitcnt vmcnt(28)
    v_mfma_f32_32x32x16_bf16 v[160:175], v[200:203], v[24:27], v[160:175]
    v_mfma_f32_32x32x16_bf16 v[176:191], v[200:203], v[28:31], v[176:191]
    v_mfma_f32_32x32x16_bf16 v[224:239], v[204:207], v[24:27], v[224:239]
    v_mfma_f32_32x32x16_bf16 v[240:255], v[204:207], v[28:31], v[240:255]
    s_waitcnt vmcnt(24)
    v_mfma_f32_32x32x16_bf16 v[160:175], v[208:211], v[32:35], v[160:175]
    v_mfma_f32_32x32x16_bf16 v[176:191], v[208:211], v[36:39], v[176:191]
    v_mfma_f32_32x32x16_bf16 v[224:239], v[212:215], v[32:35], v[224:239]
    v_mfma_f32_32x32x16_bf16 v[240:255], v[212:215], v[36:39], v[240:255]
    s_waitcnt vmcnt(20)
    v_mfma_f32_32x32x16_bf16 v[160:175], v[216:219], v[40:43], v[160:175]
    v_mfma_f32_32x32x16_bf16 v[176:191], v[216:219], v[44:47], v[176:191]
    v_mfma_f32_32x32x16_bf16 v[224:239], v[220:223], v[40:43], v[224:239]
    v_mfma_f32_32x32x16_bf16 v[240:255], v[220:223], v[44:47], v[240:255]
    s_waitcnt vmcnt(16)
    v_mfma_f32_32x32x16_bf16 v[160:175], v[16:19], v[48:51], v[160:175]
    v_mfma_f32_32x32x16_bf16 v[176:191], v[16:19], v[52:55], v[176:191]
    v_mfma_f32_32x32x16_bf16 v[224:239], v[20:23], v[48:51], v[224:239]
    v_mfma_f32_32x32x16_bf16 v[240:255], v[20:23], v[52:55], v[240:255]
    s_lshl_b32 s17, s12, 1
    s_or_b32 s17, s17, s13
    s_barrier
    s_xor_b32 s18, s17, 1
    s_mul_i32 s18, s18, 12288
    v_add_u32 v4, s18, v3
    s_nop 3
    ds_write_b128 v4, v[176:179] offset:0
    ds_write_b128 v4, v[180:183] offset:1024
    ds_write_b128 v4, v[184:187] offset:2048
    ds_write_b128 v4, v[188:191] offset:3072
    s_xor_b32 s18, s17, 2
    s_mul_i32 s18, s18, 12288
    v_add_u32 v5, s18, v3
    ds_write_b128 v5, v[224:227] offset:4096
    ds_write_b128 v5, v[228:231] offset:5120
    ds_write_b128 v5, v[232:235] offset:6144
    ds_write_b128 v5, v[236:239] offset:7168
    s_xor_b32 s18, s17, 3
    s_mul_i32 s18, s18, 12288
    v_add_u32 v6, s18, v3
    ds_write_b128 v6, v[240:243] offset:8192
    ds_write_b128 v6, v[244:247] offset:9216
    ds_write_b128 v6, v[248:251] offset:10240
    ds_write_b128 v6, v[252:255] offset:11264
    s_branch L_G2_ep
L_G2_tb:
    v_mfma_f32_32x32x16_bf16 v[160:175], v[56:59], v[128:131], v[160:175]
    v_mfma_f32_32x32x16_bf16 v[176:191], v[56:59], v[132:135], v[176:191]
    v_mfma_f32_32x32x16_bf16 v[224:239], v[60:63], v[128:131], v[224:239]
    v_mfma_f32_32x32x16_bf16 v[240:255], v[60:63], v[132:135], v[240:255]
    v_mfma_f32_32x32x16_bf16 v[160:175], v[136:139], v[144:147], v[160:175]
    v_mfma_f32_32x32x16_bf16 v[176:191], v[136:139], v[148:151], v[176:191]
    v_mfma_f32_32x32x16_bf16 v[224:239], v[140:143], v[144:147], v[224:239]
    v_mfma_f32_32x32x16_bf16 v[240:255], v[140:143], v[148:151], v[240:255]
    s_waitcnt vmcnt(16)
    v_mfma_f32_32x32x16_bf16 v[160:175], v[152:155], v[192:195], v[160:175]
    v_mfma_f32_32x32x16_bf16 v[176:191], v[152:155], v[196:199], v[176:191]
    v_mfma_f32_32x32x16_bf16 v[224:239], v[156:159], v[192:195], v[224:239]
    v_mfma_f32_32x32x16_bf16 v[240:255], v[156:159], v[196:199], v[240:255]
    s_waitcnt vmcnt(12)
    v_mfma_f32_32x32x16_bf16 v[160:175], v[200:203], v[24:27], v[160:175]
    v_mfma_f32_32x32x16_bf16 v[176:191], v[200:203], v[28:31], v[176:191]
    v_mfma_f32_32x32x16_bf16 v[224:239], v[204:207], v[24:27], v[224:239]
    v_mfma_f32_32x32x16_bf16 v[240:255], v[204:207], v[28:31], v[240:255]
    s_waitcnt vmcnt(8)
    v_mfma_f32_32x32x16_bf16 v[160:175], v[208:211], v[32:35], v[160:175]
    v_mfma_f32_32x32x16_bf16 v[176:191], v[208:211], v[36:39], v[176:191]
    v_mfma_f32_32x32x16_bf16 v[224:239], v[212:215], v[32:35], v[224:239]
    v_mfma_f32_32x32x16_bf16 v[240:255], v[212:215], v[36:39], v[240:255]
    s_waitcnt vmcnt(4)
    v_mfma_f32_32x32x16_bf16 v[160:175], v[216:219], v[40:43], v[160:175]
    v_mfma_f32_32x32x16_bf16 v[176:191], v[216:219], v[44:47], v[176:191]
    v_mfma_f32_32x32x16_bf16 v[224:239], v[220:223], v[40:43], v[224:239]
    v_mfma_f32_32x32x16_bf16 v[240:255], v[220:223], v[44:47], v[240:255]
    s_waitcnt vmcnt(0)
    v_mfma_f32_32x32x16_bf16 v[160:175], v[16:19], v[48:51], v[160:175]
    v_mfma_f32_32x32x16_bf16 v[176:191], v[16:19], v[52:55], v[176:191]
    v_mfma_f32_32x32x16_bf16 v[224:239], v[20:23], v[48:51], v[224:239]
    v_mfma_f32_32x32x16_bf16 v[240:255], v[20:23], v[52:55], v[240:255]
    s_lshl_b32 s17, s12, 1
    s_or_b32 s17, s17, s13
    s_barrier
    s_xor_b32 s18, s17, 1
    s_mul_i32 s18, s18, 12288
    v_add_u32 v4, s18, v3
    s_nop 3
    ds_write_b128 v4, v[176:179] offset:0
    ds_write_b128 v4, v[180:183] offset:1024
    ds_write_b128 v4, v[184:187] offset:2048
    ds_write_b128 v4, v[188:191] offset:3072
    s_xor_b32 s18, s17, 2
    s_mul_i32 s18, s18, 12288
    v_add_u32 v5, s18, v3
    ds_write_b128 v5, v[224:227] offset:4096
    ds_write_b128 v5, v[228:231] offset:5120
    ds_write_b128 v5, v[232:235] offset:6144
    ds_write_b128 v5, v[236:239] offset:7168
    s_xor_b32 s18, s17, 3
    s_mul_i32 s18, s18, 12288
    v_add_u32 v6, s18, v3
    ds_write_b128 v6, v[240:243] offset:8192
    ds_write_b128 v6, v[244:247] offset:9216
    ds_write_b128 v6, v[248:251] offset:10240
    ds_write_b128 v6, v[252:255] offset:11264
    s_mov_b32 s96, 0
L_G2_p3:
    global_load_dword v14, v13, s[6:7] sc0 sc1
    s_waitcnt vmcnt(0)
    v_cmp_ne_u32 vcc, 1, v14
    s_cbranch_vccz L_G2_p3_ok
    s_add_u32 s96, s96, 1
    s_cmp_lt_u32 s96, 131072
    s_cbranch_scc0 L_G2_p3_ok
    s_sleep 2
    s_branch L_G2_p3
L_G2_p3_ok:
    global_load_ushort v72, v11, s[6:7]
    v_add_u32 v11, 0x1000, v11
    global_load_ushort v73, v11, s[6:7]
    v_add_u32 v11, 0x1000, v11
    global_load_ushort v74, v11, s[6:7]
    v_add_u32 v11, 0x1000, v11
    global_load_ushort v75, v11, s[6:7]
    v_add_u32 v11, 0x1000, v11
    global_load_ushort v76, v11, s[6:7]
    v_add_u32 v11, 0x1000, v11
    global_load_ushort v77, v11, s[6:7]
    v_add_u32 v11, 0x1000, v11
    global_load_ushort v78, v11, s[6:7]
    v_add_u32 v11, 0x1000, v11
    global_load_ushort v79, v11, s[6:7]
    v_add_u32 v11, 0x1000, v11
    global_load_ushort v80, v11, s[6:7]
    v_add_u32 v11, 0x1000, v11
    global_load_ushort v81, v11, s[6:7]
    v_add_u32 v11, 0x1000, v11
    global_load_ushort v82, v11, s[6:7]
    v_add_u32 v11, 0x1000, v11
    global_load_ushort v83, v11, s[6:7]
    v_add_u32 v11, 0x1000, v11
    global_load_ushort v84, v11, s[6:7]
    v_add_u32 v11, 0x1000, v11
    global_load_ushort v85, v11, s[6:7]
    v_add_u32 v11, 0x1000, v11
    global_load_ushort v86, v11, s[6:7]
    v_add_u32 v11, 0x1000, v11
    global_load_ushort v87, v11, s[6:7]
L_G2_ep:
    s_mul_i32 s18, s17, 12288
    v_add_u32 v12, s18, v3
    s_waitcnt lgkmcnt(0)
    s_barrier
    ds_read_b128 v[16:19], v12 offset:0
    ds_read_b128 v[20:23], v12 offset:1024
    ds_read_b128 v[24:27], v12 offset:2048
    ds_read_b128 v[28:31], v12 offset:3072
    ds_read_b128 v[32:35], v12 offset:4096
    ds_read_b128 v[36:39], v12 offset:5120
    ds_read_b128 v[40:43], v12 offset:6144
    ds_read_b128 v[44:47], v12 offset:7168
    ds_read_b128 v[48:51], v12 offset:8192
    ds_read_b128 v[52:55], v12 offset:9216
    ds_read_b128 v[56:59], v12 offset:10240
    ds_read_b128 v[60:63], v12 offset:11264
    s_waitcnt vmcnt(0)
    v_lshlrev_b32 v72, 16, v72
    v_lshlrev_b32 v73, 16, v73
    v_lshlrev_b32 v74, 16, v74
    v_lshlrev_b32 v75, 16, v75
    v_lshlrev_b32 v76, 16, v76
    v_lshlrev_b32 v77, 16, v77
    v_lshlrev_b32 v78, 16, v78
    v_lshlrev_b32 v79, 16, v79
    v_lshlrev_b32 v80, 16, v80
    v_lshlrev_b32 v81, 16, v81
    v_lshlrev_b32 v82, 16, v82
    v_lshlrev_b32 v83, 16, v83
    v_lshlrev_b32 v84, 16, v84
    v_lshlrev_b32 v85, 16, v85
    v_lshlrev_b32 v86, 16, v86
    v_lshlrev_b32 v87, 16, v87
    v_lshlrev_b32 v96, 16, v64
    v_and_b32 v97, 0xffff0000, v64
    v_lshlrev_b32 v98, 16, v65
    v_and_b32 v99, 0xffff0000, v65
    v_lshlrev_b32 v100, 16, v66
    v_and_b32 v101, 0xffff0000, v66
    v_lshlrev_b32 v102, 16, v67
    v_and_b32 v103, 0xffff0000, v67
    v_lshlrev_b32 v104, 16, v68
    v_and_b32 v105, 0xffff0000, v68
    v_lshlrev_b32 v106, 16, v69
    v_and_b32 v107, 0xffff0000, v69
    v_lshlrev_b32 v108, 16, v70
    v_and_b32 v109, 0xffff0000, v70
    v_lshlrev_b32 v110, 16, v71
    v_and_b32 v111, 0xffff0000, v71
    v_add_f32 v72, v72, v96
    v_add_f32 v73, v73, v97
    v_add_f32 v74, v74, v98
    v_add_f32 v75, v75, v99
    v_add_f32 v76, v76, v100
    v_add_f32 v77, v77, v101
    v_add_f32 v78, v78, v102
    v_add_f32 v79, v79, v103
    v_add_f32 v80, v80, v104
    v_add_f32 v81, v81, v105
    v_add_f32 v82, v82, v106
    v_add_f32 v83, v83, v107
    v_add_f32 v84, v84, v108
    v_add_f32 v85, v85, v109
    v_add_f32 v86, v86, v110
    v_add_f32 v87, v87, v111
    v_cvt_pk_bf16_f32 v64, v72, v73
    v_cvt_pk_bf16_f32 v65, v74, v75
    v_cvt_pk_bf16_f32 v66, v76, v77
    v_cvt_pk_bf16_f32 v67, v78, v79
    v_cvt_pk_bf16_f32 v68, v80, v81
    v_cvt_pk_bf16_f32 v69, v82, v83
    v_cvt_pk_bf16_f32 v70, v84, v85
    v_cvt_pk_bf16_f32 v71, v86, v87
    v_lshlrev_b32 v72, 16, v64
    v_and_b32 v73, 0xffff0000, v64
    v_lshlrev_b32 v74, 16, v65
    v_and_b32 v75, 0xffff0000, v65
    v_lshlrev_b32 v76, 16, v66
    v_and_b32 v77, 0xffff0000, v66
    v_lshlrev_b32 v78, 16, v67
    v_and_b32 v79, 0xffff0000, v67
    v_lshlrev_b32 v80, 16, v68
    v_and_b32 v81, 0xffff0000, v68
    v_lshlrev_b32 v82, 16, v69
    v_and_b32 v83, 0xffff0000, v69
    v_lshlrev_b32 v84, 16, v70
    v_and_b32 v85, 0xffff0000, v70
    v_lshlrev_b32 v86, 16, v71
    v_and_b32 v87, 0xffff0000, v71
    s_waitcnt lgkmcnt(0)
    v_add_f32 v16, v16, v32
    v_add_f32 v160, v160, v48
    v_add_f32 v17, v17, v33
    v_add_f32 v161, v161, v49
    v_add_f32 v18, v18, v34
    v_add_f32 v162, v162, v50
    v_add_f32 v19, v19, v35
    v_add_f32 v163, v163, v51
    v_add_f32 v20, v20, v36
    v_add_f32 v164, v164, v52
    v_add_f32 v21, v21, v37
    v_add_f32 v165, v165, v53
    v_add_f32 v22, v22, v38
    v_add_f32 v166, v166, v54
    v_add_f32 v23, v23, v39
    v_add_f32 v167, v167, v55
    v_add_f32 v24, v24, v40
    v_add_f32 v168, v168, v56
    v_add_f32 v25, v25, v41
    v_add_f32 v169, v169, v57
    v_add_f32 v26, v26, v42
    v_add_f32 v170, v170, v58
    v_add_f32 v27, v27, v43
    v_add_f32 v171, v171, v59
    v_add_f32 v28, v28, v44
    v_add_f32 v172, v172, v60
    v_add_f32 v29, v29, v45
    v_add_f32 v173, v173, v61
    v_add_f32 v30, v30, v46
    v_add_f32 v174, v174, v62
    v_add_f32 v31, v31, v47
    v_add_f32 v175, v175, v63
    v_add_f32 v160, v160, v16
    v_add_f32 v161, v161, v17
    v_add_f32 v162, v162, v18
    v_add_f32 v163, v163, v19
    v_add_f32 v164, v164, v20
    v_add_f32 v165, v165, v21
    v_add_f32 v166, v166, v22
    v_add_f32 v167, v167, v23
    v_add_f32 v168, v168, v24
    v_add_f32 v169, v169, v25
    v_add_f32 v170, v170, v26
    v_add_f32 v171, v171, v27
    v_add_f32 v172, v172, v28
    v_add_f32 v173, v173, v29
    v_add_f32 v174, v174, v30
    v_add_f32 v175, v175, v31
    v_cvt_pk_bf16_f32 v64, v160, v161
    v_cvt_pk_bf16_f32 v65, v162, v163
    v_cvt_pk_bf16_f32 v66, v164, v165
    v_cvt_pk_bf16_f32 v67, v166, v167
    v_cvt_pk_bf16_f32 v68, v168, v169
    v_cvt_pk_bf16_f32 v69, v170, v171
    v_cvt_pk_bf16_f32 v70, v172, v173
    v_cvt_pk_bf16_f32 v71, v174, v175
    v_lshlrev_b32 v160, 16, v64
    v_and_b32 v161, 0xffff0000, v64
    v_lshlrev_b32 v162, 16, v65
    v_and_b32 v163, 0xffff0000, v65
    v_lshlrev_b32 v164, 16, v66
    v_and_b32 v165, 0xffff0000, v66
    v_lshlrev_b32 v166, 16, v67
    v_and_b32 v167, 0xffff0000, v67
    v_lshlrev_b32 v168, 16, v68
    v_and_b32 v169, 0xffff0000, v68
    v_lshlrev_b32 v170, 16, v69
    v_and_b32 v171, 0xffff0000, v69
    v_lshlrev_b32 v172, 16, v70
    v_and_b32 v173, 0xffff0000, v70
    v_lshlrev_b32 v174, 16, v71
    v_and_b32 v175, 0xffff0000, v71
    v_add_f32 v72, v72, v160
    v_add_f32 v73, v73, v161
    v_add_f32 v74, v74, v162
    v_add_f32 v75, v75, v163
    v_add_f32 v76, v76, v164
    v_add_f32 v77, v77, v165
    v_add_f32 v78, v78, v166
    v_add_f32 v79, v79, v167
    v_add_f32 v80, v80, v168
    v_add_f32 v81, v81, v169
    v_add_f32 v82, v82, v170
    v_add_f32 v83, v83, v171
    v_add_f32 v84, v84, v172
    v_add_f32 v85, v85, v173
    v_add_f32 v86, v86, v174
    v_add_f32 v87, v87, v175
    v_cvt_pk_bf16_f32 v64, v72, v73
    v_cvt_pk_bf16_f32 v65, v74, v75
    v_cvt_pk_bf16_f32 v66, v76, v77
    v_cvt_pk_bf16_f32 v67, v78, v79
    v_cvt_pk_bf16_f32 v68, v80, v81
    v_cvt_pk_bf16_f32 v69, v82, v83
    v_cvt_pk_bf16_f32 v70, v84, v85
    v_cvt_pk_bf16_f32 v71, v86, v87
    global_store_dwordx4 v10, v[64:67], s[8:9]
    global_store_dwordx4 v10, v[68:71], s[8:9] offset:16
    s_endpgm
L_B:
    s_setprio 2
    s_sub_u32 s8, s2, 256
    s_and_b32 s3, s8, 7
    s_lshl_b32 s3, s3, 5
    s_lshr_b32 s8, s8, 3
    s_add_u32 s3, s3, s8
    s_load_dwordx4 s[8:11], s[0:1], 8
    s_load_dwordx4 s[20:23], s[0:1], 24
    s_load_dwordx4 s[16:19], s[0:1], 40
    v_and_b32 v3, 31, v1
    v_lshl_add_u32 v3, v2, 5, v3
    v_lshlrev_b32 v12, 4, v3
    s_lshl_b32 s24, s3, 8
    v_add_u32 v3, s24, v3
    v_lshlrev_b32 v3, 1, v3
    s_lshl_b32 s24, s3, 2
    v_mov_b32 v4, s24
    s_waitcnt lgkmcnt(0)
    global_load_ushort v5, v3, s[8:9]
    global_load_ushort v6, v3, s[10:11]
    global_load_ushort v7, v3, s[20:21]
    global_load_ushort v8, v3, s[22:23]
    global_load_ushort v9, v4, s[16:17]
    global_load_ushort v140, v3, s[8:9] offset:256
    global_load_ushort v141, v3, s[10:11] offset:256
    global_load_ushort v142, v3, s[20:21] offset:256
    global_load_ushort v143, v3, s[22:23] offset:256
    global_load_ushort v144, v4, s[16:17] offset:2
    global_load_dword v145, v4, s[18:19]
    global_load_dword v120, v121, s[6:7] sc0 sc1
    s_mov_b32 s94, 0
    s_cmp_lg_u32 s2, 511
    s_cbranch_scc1 L_B_nc
    s_cmp_lg_u32 s14, 0
    s_cbranch_scc1 L_B_nc
    s_setprio 3
    s_mov_b32 s94, 1
    v_lshlrev_b32 v16, 4, v1
    v_add_u32 v16, 0x2000000, v16
    v_mov_b32 v20, 0
    v_mov_b32 v21, 0
    v_mov_b32 v22, 0
    v_mov_b32 v23, 0
    v_add_u32 v182, 0x1000, v16
    global_store_dwordx4 v16, v[20:23], s[6:7] sc0 sc1
    global_store_dwordx4 v16, v[20:23], s[6:7] offset:1024 sc0 sc1
    global_store_dwordx4 v16, v[20:23], s[6:7] offset:2048 sc0 sc1
    global_store_dwordx4 v16, v[20:23], s[6:7] offset:3072 sc0 sc1
    global_store_dwordx4 v182, v[20:23], s[6:7] sc0 sc1
    global_store_dwordx4 v182, v[20:23], s[6:7] offset:1024 sc0 sc1
    v_lshlrev_b32 v180, 8, v1
    v_add_u32 v180, 0x2010000, v180
    global_load_dword v181, v180, s[6:7] sc0 sc1
    v_mov_b32 v32, 0x20017fc
    v_mov_b32 v33, 1
    s_waitcnt vmcnt(0)
    v_add_u32 v181, 1, v181
    global_store_dword v180, v181, s[6:7] sc0 sc1
    global_store_dword v32, v33, s[6:7] sc0 sc1
    s_setprio 2
L_B_nc:
    v_and_b32 v11, 15, v1
    v_cvt_f32_u32 v10, v11
    v_cvt_f32_u32 v11, v11
    v_lshrrev_b32 v13, 4, v1
    v_lshlrev_b32 v13, 4, v13
    v_lshl_add_u32 v13, v2, 9, v13
    v_lshlrev_b32 v4, 3, v0
    v_sub_u32 v4, 0x7ff, v4
    v_subrev_u32 v146, 0, v4
    v_or_b32 v24, 1, v146
    v_ffbh_u32 v24, v24
    v_sub_u32 v24, 24, v24
    v_med3_i32 v24, v24, 0, 3
    v_bfe_u32 v25, v146, v24, 1
    v_bfm_b32 v26, v24, 0
    v_lshl_add_u32 v26, v146, 1, v26
    v_add_u32 v26, v26, v25
    v_add_u32 v25, 1, v24
    v_lshrrev_b32 v26, v25, v26
    v_lshl_add_u32 v24, v24, 8, v26
    v_lshrrev_b32 v26, 8, v26
    v_lshl_add_u32 v24, v26, 7, v24
    v_lshlrev_b32 v146, 2, v24
    v_subrev_u32 v147, 1, v4
    v_or_b32 v24, 1, v147
    v_ffbh_u32 v24, v24
    v_sub_u32 v24, 24, v24
    v_med3_i32 v24, v24, 0, 3
    v_bfe_u32 v25, v147, v24, 1
    v_bfm_b32 v26, v24, 0
    v_lshl_add_u32 v26, v147, 1, v26
    v_add_u32 v26, v26, v25
    v_add_u32 v25, 1, v24
    v_lshrrev_b32 v26, v25, v26
    v_lshl_add_u32 v24, v24, 8, v26
    v_lshrrev_b32 v26, 8, v26
    v_lshl_add_u32 v24, v26, 7, v24
    v_lshlrev_b32 v147, 2, v24
    v_subrev_u32 v148, 2, v4
    v_or_b32 v24, 1, v148
    v_ffbh_u32 v24, v24
    v_sub_u32 v24, 24, v24
    v_med3_i32 v24, v24, 0, 3
    v_bfe_u32 v25, v148, v24, 1
    v_bfm_b32 v26, v24, 0
    v_lshl_add_u32 v26, v148, 1, v26
    v_add_u32 v26, v26, v25
    v_add_u32 v25, 1, v24
    v_lshrrev_b32 v26, v25, v26
    v_lshl_add_u32 v24, v24, 8, v26
    v_lshrrev_b32 v26, 8, v26
    v_lshl_add_u32 v24, v26, 7, v24
    v_lshlrev_b32 v148, 2, v24
    v_subrev_u32 v149, 3, v4
    v_or_b32 v24, 1, v149
    v_ffbh_u32 v24, v24
    v_sub_u32 v24, 24, v24
    v_med3_i32 v24, v24, 0, 3
    v_bfe_u32 v25, v149, v24, 1
    v_bfm_b32 v26, v24, 0
    v_lshl_add_u32 v26, v149, 1, v26
    v_add_u32 v26, v26, v25
    v_add_u32 v25, 1, v24
    v_lshrrev_b32 v26, v25, v26
    v_lshl_add_u32 v24, v24, 8, v26
    v_lshrrev_b32 v26, 8, v26
    v_lshl_add_u32 v24, v26, 7, v24
    v_lshlrev_b32 v149, 2, v24
    s_cmp_eq_u32 s94, 0
    s_cbranch_scc1 L_beat1
    v_add_u32 v181, 1, v181
    global_store_dword v180, v181, s[6:7] sc0 sc1
L_beat1:
    v_subrev_u32 v150, 4, v4
    v_or_b32 v24, 1, v150
    v_ffbh_u32 v24, v24
    v_sub_u32 v24, 24, v24
    v_med3_i32 v24, v24, 0, 3
    v_bfe_u32 v25, v150, v24, 1
    v_bfm_b32 v26, v24, 0
    v_lshl_add_u32 v26, v150, 1, v26
    v_add_u32 v26, v26, v25
    v_add_u32 v25, 1, v24
    v_lshrrev_b32 v26, v25, v26
    v_lshl_add_u32 v24, v24, 8, v26
    v_lshrrev_b32 v26, 8, v26
    v_lshl_add_u32 v24, v26, 7, v24
    v_lshlrev_b32 v150, 2, v24
    v_subrev_u32 v151, 5, v4
    v_or_b32 v24, 1, v151
    v_ffbh_u32 v24, v24
    v_sub_u32 v24, 24, v24
    v_med3_i32 v24, v24, 0, 3
    v_bfe_u32 v25, v151, v24, 1
    v_bfm_b32 v26, v24, 0
    v_lshl_add_u32 v26, v151, 1, v26
    v_add_u32 v26, v26, v25
    v_add_u32 v25, 1, v24
    v_lshrrev_b32 v26, v25, v26
    v_lshl_add_u32 v24, v24, 8, v26
    v_lshrrev_b32 v26, 8, v26
    v_lshl_add_u32 v24, v26, 7, v24
    v_lshlrev_b32 v151, 2, v24
    v_subrev_u32 v152, 6, v4
    v_or_b32 v24, 1, v152
    v_ffbh_u32 v24, v24
    v_sub_u32 v24, 24, v24
    v_med3_i32 v24, v24, 0, 3
    v_bfe_u32 v25, v152, v24, 1
    v_bfm_b32 v26, v24, 0
    v_lshl_add_u32 v26, v152, 1, v26
    v_add_u32 v26, v26, v25
    v_add_u32 v25, 1, v24
    v_lshrrev_b32 v26, v25, v26
    v_lshl_add_u32 v24, v24, 8, v26
    v_lshrrev_b32 v26, 8, v26
    v_lshl_add_u32 v24, v26, 7, v24
    v_lshlrev_b32 v152, 2, v24
    v_subrev_u32 v153, 7, v4
    v_or_b32 v24, 1, v153
    v_ffbh_u32 v24, v24
    v_sub_u32 v24, 24, v24
    v_med3_i32 v24, v24, 0, 3
    v_bfe_u32 v25, v153, v24, 1
    v_bfm_b32 v26, v24, 0
    v_lshl_add_u32 v26, v153, 1, v26
    v_add_u32 v26, v26, v25
    v_add_u32 v25, 1, v24
    v_lshrrev_b32 v26, v25, v26
    v_lshl_add_u32 v24, v24, 8, v26
    v_lshrrev_b32 v26, 8, v26
    v_lshl_add_u32 v24, v26, 7, v24
    v_lshlrev_b32 v153, 2, v24
    v_lshlrev_b32 v154, 12, v2
    v_lshl_add_u32 v154, v1, 2, v154
    v_lshlrev_b32 v155, 2, v0
    v_bfe_u32 v25, v0, 4, 2
    v_bfe_u32 v26, v0, 2, 2
    v_and_b32 v27, 3, v0
    v_lshlrev_b32 v156, 10, v2
    v_lshl_add_u32 v156, v25, 6, v156
    v_lshl_add_u32 v156, v26, 8, v156
    v_lshl_add_u32 v156, v27, 4, v156
    v_and_b32 v157, 15, v1
    v_lshlrev_b32 v157, 6, v157
    v_lshlrev_b32 v158, 4, v0
    v_min_u32 v159, 254, v0
    v_lshlrev_b32 v159, 4, v159
    s_mov_b32 s95, 0
    s_waitcnt vmcnt(0)
    s_cmp_eq_u32 s94, 0
    s_cbranch_scc1 L_beat2
    v_add_u32 v181, 1, v181
    global_store_dword v180, v181, s[6:7] sc0 sc1
L_beat2:
L_kg:
    v_mov_b32 v48, 0
    v_mov_b32 v49, 0
    v_mov_b32 v50, 0
    v_mov_b32 v51, 0
    v_mov_b32 v52, 0
    v_mov_b32 v53, 0
    v_mov_b32 v54, 0
    v_mov_b32 v55, 0
    v_mov_b32 v56, 0
    v_mov_b32 v57, 0
    v_mov_b32 v58, 0
    v_mov_b32 v59, 0
    v_mov_b32 v60, 0
    v_mov_b32 v61, 0
    v_mov_b32 v62, 0
    v_mov_b32 v63, 0
    v_mov_b32 v64, 0
    v_lshlrev_b32 v5, 16, v5
    v_lshlrev_b32 v6, 16, v6
    v_lshlrev_b32 v7, 16, v7
    v_lshlrev_b32 v8, 16, v8
    v_lshlrev_b32 v9, 16, v9
    v_mul_f32 v5, 0x3fb8aa3b, v5
    v_mul_f32 v9, 0x3fb8aa3b, v9
    v_exp_f32 v5, v5
    v_exp_f32 v9, v9
    s_nop 0
    v_cvt_pk_bf16_f32 v5, v5, v9
    v_and_b32 v9, 0xffff0000, v5
    v_lshlrev_b32 v5, 16, v5
    v_mul_f32 v4, v5, v9
    v_mul_f32 v5, v6, v9
    v_mul_f32 v6, v7, v9
    v_mul_f32 v7, v8, v9
    v_mul_f32 v4, 0xbfb8aa3b, v4
    v_mul_f32 v5, 0x3e22f983, v5
    v_mul_f32 v6, 0x46000000, v6
    v_mul_f32 v7, 0x46000000, v7
    ds_write_b128 v12, v[4:7] offset:20480
    s_waitcnt lgkmcnt(0)
    ds_read_b128 v[16:19], v13 offset:20480
    ds_read_b128 v[20:23], v13 offset:20544
    ds_read_b128 v[24:27], v13 offset:20608
    ds_read_b128 v[28:31], v13 offset:20672
    ds_read_b128 v[32:35], v13 offset:20736
    ds_read_b128 v[36:39], v13 offset:20800
    ds_read_b128 v[40:43], v13 offset:20864
    ds_read_b128 v[44:47], v13 offset:20928
    s_waitcnt lgkmcnt(7)
    v_pk_mul_f32 v[66:67], v[16:17], v[10:11]
    v_fract_f32 v67, v67
    v_exp_f32 v70, v66
    v_cos_f32 v72, v67
    v_sin_f32 v73, v67
    s_nop 0
    v_pk_mul_f32 v[76:77], v[70:71], v[72:73] op_sel:[0,0] op_sel_hi:[0,1]
    v_cvt_pk_f16_f32 v100, v76, v77
    v_pk_mul_f32 v[82:83], v[76:77], v[76:77] op_sel:[0,0] op_sel_hi:[0,1]
    v_pk_fma_f32 v[76:77], v[76:77], v[76:77], v[82:83] op_sel:[1,1,0] op_sel_hi:[1,0,1] neg_lo:[0,1,0]
    v_cvt_pk_f16_f32 v104, v76, v77
    v_pk_mul_f32 v[82:83], v[76:77], v[76:77] op_sel:[0,0] op_sel_hi:[0,1]
    v_pk_fma_f32 v[76:77], v[76:77], v[76:77], v[82:83] op_sel:[1,1,0] op_sel_hi:[1,0,1] neg_lo:[0,1,0]
    v_cvt_pk_f16_f32 v108, v76, v77
    v_pk_mul_f32 v[82:83], v[76:77], v[76:77] op_sel:[0,0] op_sel_hi:[0,1]
    v_pk_fma_f32 v[76:77], v[76:77], v[76:77], v[82:83] op_sel:[1,1,0] op_sel_hi:[1,0,1] neg_lo:[0,1,0]
    v_cvt_pk_f16_f32 v112, v76, v77
    v_pk_mul_f32 v[82:83], v[76:77], v[76:77] op_sel:[0,0] op_sel_hi:[0,1]
    v_pk_fma_f32 v[76:77], v[76:77], v[76:77], v[82:83] op_sel:[1,1,0] op_sel_hi:[1,0,1] neg_lo:[0,1,0]
    v_pk_mul_f32 v[80:81], v[18:19], v[76:77] op_sel:[0,0] op_sel_hi:[0,1] neg_hi:[1,0]
    v_pk_fma_f32 v[80:81], v[18:19], v[76:77], v[80:81] op_sel:[1,1,0] op_sel_hi:[1,0,1] neg_lo:[0,1,0] neg_hi:[0,1,0]
    v_pk_mul_f32 v[82:83], v[76:77], v[76:77] op_sel:[0,0] op_sel_hi:[0,1]
    v_pk_fma_f32 v[76:77], v[76:77], v[76:77], v[82:83] op_sel:[1,1,0] op_sel_hi:[1,0,1] neg_lo:[0,1,0]
    v_cvt_pk_f16_f32 v84, v80, v81
    v_pk_mul_f32 v[80:81], v[18:19], v[76:77] op_sel:[0,0] op_sel_hi:[0,1] neg_hi:[1,0]
    v_pk_fma_f32 v[80:81], v[18:19], v[76:77], v[80:81] op_sel:[1,1,0] op_sel_hi:[1,0,1] neg_lo:[0,1,0] neg_hi:[0,1,0]
    v_pk_mul_f32 v[82:83], v[76:77], v[76:77] op_sel:[0,0] op_sel_hi:[0,1]
    v_pk_fma_f32 v[76:77], v[76:77], v[76:77], v[82:83] op_sel:[1,1,0] op_sel_hi:[1,0,1] neg_lo:[0,1,0]
    v_cvt_pk_f16_f32 v88, v80, v81
    v_pk_mul_f32 v[80:81], v[18:19], v[76:77] op_sel:[0,0] op_sel_hi:[0,1] neg_hi:[1,0]
    v_pk_fma_f32 v[80:81], v[18:19], v[76:77], v[80:81] op_sel:[1,1,0] op_sel_hi:[1,0,1] neg_lo:[0,1,0] neg_hi:[0,1,0]
    v_pk_mul_f32 v[82:83], v[76:77], v[76:77] op_sel:[0,0] op_sel_hi:[0,1]
    v_pk_fma_f32 v[76:77], v[76:77], v[76:77], v[82:83] op_sel:[1,1,0] op_sel_hi:[1,0,1] neg_lo:[0,1,0]
    v_cvt_pk_f16_f32 v92, v80, v81
    v_pk_mul_f32 v[80:81], v[18:19], v[76:77] op_sel:[0,0] op_sel_hi:[0,1] neg_hi:[1,0]
    v_pk_fma_f32 v[80:81], v[18:19], v[76:77], v[80:81] op_sel:[1,1,0] op_sel_hi:[1,0,1] neg_lo:[0,1,0] neg_hi:[0,1,0]
    v_pk_mul_f32 v[82:83], v[76:77], v[76:77] op_sel:[0,0] op_sel_hi:[0,1]
    v_pk_fma_f32 v[76:77], v[76:77], v[76:77], v[82:83] op_sel:[1,1,0] op_sel_hi:[1,0,1] neg_lo:[0,1,0]
    v_cvt_pk_f16_f32 v96, v80, v81
    v_fma_f32 v64, v18, v76, v64
    v_fma_f32 v64, -v19, v77, v64
    s_cmp_eq_u32 s94, 0
    s_cbranch_scc1 L_beat3
    v_add_u32 v181, 1, v181
    global_store_dword v180, v181, s[6:7] sc0 sc1
L_beat3:
    s_waitcnt lgkmcnt(6)
    v_pk_mul_f32 v[66:67], v[20:21], v[10:11]
    v_fract_f32 v67, v67
    v_exp_f32 v70, v66
    v_cos_f32 v72, v67
    v_sin_f32 v73, v67
    s_nop 0
    v_pk_mul_f32 v[76:77], v[70:71], v[72:73] op_sel:[0,0] op_sel_hi:[0,1]
    v_cvt_pk_f16_f32 v101, v76, v77
    v_pk_mul_f32 v[82:83], v[76:77], v[76:77] op_sel:[0,0] op_sel_hi:[0,1]
    v_pk_fma_f32 v[76:77], v[76:77], v[76:77], v[82:83] op_sel:[1,1,0] op_sel_hi:[1,0,1] neg_lo:[0,1,0]
    v_cvt_pk_f16_f32 v105, v76, v77
    v_pk_mul_f32 v[82:83], v[76:77], v[76:77] op_sel:[0,0] op_sel_hi:[0,1]
    v_pk_fma_f32 v[76:77], v[76:77], v[76:77], v[82:83] op_sel:[1,1,0] op_sel_hi:[1,0,1] neg_lo:[0,1,0]
    v_cvt_pk_f16_f32 v109, v76, v77
    v_pk_mul_f32 v[82:83], v[76:77], v[76:77] op_sel:[0,0] op_sel_hi:[0,1]
    v_pk_fma_f32 v[76:77], v[76:77], v[76:77], v[82:83] op_sel:[1,1,0] op_sel_hi:[1,0,1] neg_lo:[0,1,0]
    v_cvt_pk_f16_f32 v113, v76, v77
    v_pk_mul_f32 v[82:83], v[76:77], v[76:77] op_sel:[0,0] op_sel_hi:[0,1]
    v_pk_fma_f32 v[76:77], v[76:77], v[76:77], v[82:83] op_sel:[1,1,0] op_sel_hi:[1,0,1] neg_lo:[0,1,0]
    v_pk_mul_f32 v[80:81], v[22:23], v[76:77] op_sel:[0,0] op_sel_hi:[0,1] neg_hi:[1,0]
    v_pk_fma_f32 v[80:81], v[22:23], v[76:77], v[80:81] op_sel:[1,1,0] op_sel_hi:[1,0,1] neg_lo:[0,1,0] neg_hi:[0,1,0]
    v_pk_mul_f32 v[82:83], v[76:77], v[76:77] op_sel:[0,0] op_sel_hi:[0,1]
    v_pk_fma_f32 v[76:77], v[76:77], v[76:77], v[82:83] op_sel:[1,1,0] op_sel_hi:[1,0,1] neg_lo:[0,1,0]
    v_cvt_pk_f16_f32 v85, v80, v81
    v_pk_mul_f32 v[80:81], v[22:23], v[76:77] op_sel:[0,0] op_sel_hi:[0,1] neg_hi:[1,0]
    v_pk_fma_f32 v[80:81], v[22:23], v[76:77], v[80:81] op_sel:[1,1,0] op_sel_hi:[1,0,1] neg_lo:[0,1,0] neg_hi:[0,1,0]
    v_pk_mul_f32 v[82:83], v[76:77], v[76:77] op_sel:[0,0] op_sel_hi:[0,1]
    v_pk_fma_f32 v[76:77], v[76:77], v[76:77], v[82:83] op_sel:[1,1,0] op_sel_hi:[1,0,1] neg_lo:[0,1,0]
    v_cvt_pk_f16_f32 v89, v80, v81
    v_pk_mul_f32 v[80:81], v[22:23], v[76:77] op_sel:[0,0] op_sel_hi:[0,1] neg_hi:[1,0]
    v_pk_fma_f32 v[80:81], v[22:23], v[76:77], v[80:81] op_sel:[1,1,0] op_sel_hi:[1,0,1] neg_lo:[0,1,0] neg_hi:[0,1,0]
    v_pk_mul_f32 v[82:83], v[76:77], v[76:77] op_sel:[0,0] op_sel_hi:[0,1]
    v_pk_fma_f32 v[76:77], v[76:77], v[76:77], v[82:83] op_sel:[1,1,0] op_sel_hi:[1,0,1] neg_lo:[0,1,0]
    v_cvt_pk_f16_f32 v93, v80, v81
    v_pk_mul_f32 v[80:81], v[22:23], v[76:77] op_sel:[0,0] op_sel_hi:[0,1] neg_hi:[1,0]
    v_pk_fma_f32 v[80:81], v[22:23], v[76:77], v[80:81] op_sel:[1,1,0] op_sel_hi:[1,0,1] neg_lo:[0,1,0] neg_hi:[0,1,0]
    v_pk_mul_f32 v[82:83], v[76:77], v[76:77] op_sel:[0,0] op_sel_hi:[0,1]
    v_pk_fma_f32 v[76:77], v[76:77], v[76:77], v[82:83] op_sel:[1,1,0] op_sel_hi:[1,0,1] neg_lo:[0,1,0]
    v_cvt_pk_f16_f32 v97, v80, v81
    v_fma_f32 v64, v22, v76, v64
    v_fma_f32 v64, -v23, v77, v64
    s_cmp_eq_u32 s94, 0
    s_cbranch_scc1 L_beat4
    v_add_u32 v181, 1, v181
    global_store_dword v180, v181, s[6:7] sc0 sc1
L_beat4:
    s_waitcnt lgkmcnt(5)
    v_pk_mul_f32 v[66:67], v[24:25], v[10:11]
    v_fract_f32 v67, v67
    v_exp_f32 v70, v66
    v_cos_f32 v72, v67
    v_sin_f32 v73, v67
    s_nop 0
    v_pk_mul_f32 v[76:77], v[70:71], v[72:73] op_sel:[0,0] op_sel_hi:[0,1]
    v_cvt_pk_f16_f32 v102, v76, v77
    v_pk_mul_f32 v[82:83], v[76:77], v[76:77] op_sel:[0,0] op_sel_hi:[0,1]
    v_pk_fma_f32 v[76:77], v[76:77], v[76:77], v[82:83] op_sel:[1,1,0] op_sel_hi:[1,0,1] neg_lo:[0,1,0]
    v_cvt_pk_f16_f32 v106, v76, v77
    v_pk_mul_f32 v[82:83], v[76:77], v[76:77] op_sel:[0,0] op_sel_hi:[0,1]
    v_pk_fma_f32 v[76:77], v[76:77], v[76:77], v[82:83] op_sel:[1,1,0] op_sel_hi:[1,0,1] neg_lo:[0,1,0]
    v_cvt_pk_f16_f32 v110, v76, v77
    v_pk_mul_f32 v[82:83], v[76:77], v[76:77] op_sel:[0,0] op_sel_hi:[0,1]
    v_pk_fma_f32 v[76:77], v[76:77], v[76:77], v[82:83] op_sel:[1,1,0] op_sel_hi:[1,0,1] neg_lo:[0,1,0]
    v_cvt_pk_f16_f32 v114, v76, v77
    v_pk_mul_f32 v[82:83], v[76:77], v[76:77] op_sel:[0,0] op_sel_hi:[0,1]
    v_pk_fma_f32 v[76:77], v[76:77], v[76:77], v[82:83] op_sel:[1,1,0] op_sel_hi:[1,0,1] neg_lo:[0,1,0]
    v_pk_mul_f32 v[80:81], v[26:27], v[76:77] op_sel:[0,0] op_sel_hi:[0,1] neg_hi:[1,0]
    v_pk_fma_f32 v[80:81], v[26:27], v[76:77], v[80:81] op_sel:[1,1,0] op_sel_hi:[1,0,1] neg_lo:[0,1,0] neg_hi:[0,1,0]
    v_pk_mul_f32 v[82:83], v[76:77], v[76:77] op_sel:[0,0] op_sel_hi:[0,1]
    v_pk_fma_f32 v[76:77], v[76:77], v[76:77], v[82:83] op_sel:[1,1,0] op_sel_hi:[1,0,1] neg_lo:[0,1,0]
    v_cvt_pk_f16_f32 v86, v80, v81
    v_pk_mul_f32 v[80:81], v[26:27], v[76:77] op_sel:[0,0] op_sel_hi:[0,1] neg_hi:[1,0]
    v_pk_fma_f32 v[80:81], v[26:27], v[76:77], v[80:81] op_sel:[1,1,0] op_sel_hi:[1,0,1] neg_lo:[0,1,0] neg_hi:[0,1,0]
    v_pk_mul_f32 v[82:83], v[76:77], v[76:77] op_sel:[0,0] op_sel_hi:[0,1]
    v_pk_fma_f32 v[76:77], v[76:77], v[76:77], v[82:83] op_sel:[1,1,0] op_sel_hi:[1,0,1] neg_lo:[0,1,0]
    v_cvt_pk_f16_f32 v90, v80, v81
    v_pk_mul_f32 v[80:81], v[26:27], v[76:77] op_sel:[0,0] op_sel_hi:[0,1] neg_hi:[1,0]
    v_pk_fma_f32 v[80:81], v[26:27], v[76:77], v[80:81] op_sel:[1,1,0] op_sel_hi:[1,0,1] neg_lo:[0,1,0] neg_hi:[0,1,0]
    v_pk_mul_f32 v[82:83], v[76:77], v[76:77] op_sel:[0,0] op_sel_hi:[0,1]
    v_pk_fma_f32 v[76:77], v[76:77], v[76:77], v[82:83] op_sel:[1,1,0] op_sel_hi:[1,0,1] neg_lo:[0,1,0]
    v_cvt_pk_f16_f32 v94, v80, v81
    v_pk_mul_f32 v[80:81], v[26:27], v[76:77] op_sel:[0,0] op_sel_hi:[0,1] neg_hi:[1,0]
    v_pk_fma_f32 v[80:81], v[26:27], v[76:77], v[80:81] op_sel:[1,1,0] op_sel_hi:[1,0,1] neg_lo:[0,1,0] neg_hi:[0,1,0]
    v_pk_mul_f32 v[82:83], v[76:77], v[76:77] op_sel:[0,0] op_sel_hi:[0,1]
    v_pk_fma_f32 v[76:77], v[76:77], v[76:77], v[82:83] op_sel:[1,1,0] op_sel_hi:[1,0,1] neg_lo:[0,1,0]
    v_cvt_pk_f16_f32 v98, v80, v81
    v_fma_f32 v64, v26, v76, v64
    v_fma_f32 v64, -v27, v77, v64
    s_cmp_eq_u32 s94, 0
    s_cbranch_scc1 L_beat5
    v_add_u32 v181, 1, v181
    global_store_dword v180, v181, s[6:7] sc0 sc1
L_beat5:
    s_waitcnt lgkmcnt(4)
    v_pk_mul_f32 v[66:67], v[28:29], v[10:11]
    v_fract_f32 v67, v67
    v_exp_f32 v70, v66
    v_cos_f32 v72, v67
    v_sin_f32 v73, v67
    s_nop 0
    v_pk_mul_f32 v[76:77], v[70:71], v[72:73] op_sel:[0,0] op_sel_hi:[0,1]
    v_cvt_pk_f16_f32 v103, v76, v77
    v_pk_mul_f32 v[82:83], v[76:77], v[76:77] op_sel:[0,0] op_sel_hi:[0,1]
    v_pk_fma_f32 v[76:77], v[76:77], v[76:77], v[82:83] op_sel:[1,1,0] op_sel_hi:[1,0,1] neg_lo:[0,1,0]
    v_cvt_pk_f16_f32 v107, v76, v77
    v_pk_mul_f32 v[82:83], v[76:77], v[76:77] op_sel:[0,0] op_sel_hi:[0,1]
    v_pk_fma_f32 v[76:77], v[76:77], v[76:77], v[82:83] op_sel:[1,1,0] op_sel_hi:[1,0,1] neg_lo:[0,1,0]
    v_cvt_pk_f16_f32 v111, v76, v77
    v_pk_mul_f32 v[82:83], v[76:77], v[76:77] op_sel:[0,0] op_sel_hi:[0,1]
    v_pk_fma_f32 v[76:77], v[76:77], v[76:77], v[82:83] op_sel:[1,1,0] op_sel_hi:[1,0,1] neg_lo:[0,1,0]
    v_cvt_pk_f16_f32 v115, v76, v77
    v_pk_mul_f32 v[82:83], v[76:77], v[76:77] op_sel:[0,0] op_sel_hi:[0,1]
    v_pk_fma_f32 v[76:77], v[76:77], v[76:77], v[82:83] op_sel:[1,1,0] op_sel_hi:[1,0,1] neg_lo:[0,1,0]
    v_pk_mul_f32 v[80:81], v[30:31], v[76:77] op_sel:[0,0] op_sel_hi:[0,1] neg_hi:[1,0]
    v_pk_fma_f32 v[80:81], v[30:31], v[76:77], v[80:81] op_sel:[1,1,0] op_sel_hi:[1,0,1] neg_lo:[0,1,0] neg_hi:[0,1,0]
    v_pk_mul_f32 v[82:83], v[76:77], v[76:77] op_sel:[0,0] op_sel_hi:[0,1]
    v_pk_fma_f32 v[76:77], v[76:77], v[76:77], v[82:83] op_sel:[1,1,0] op_sel_hi:[1,0,1] neg_lo:[0,1,0]
    v_cvt_pk_f16_f32 v87, v80, v81
    v_pk_mul_f32 v[80:81], v[30:31], v[76:77] op_sel:[0,0] op_sel_hi:[0,1] neg_hi:[1,0]
    v_pk_fma_f32 v[80:81], v[30:31], v[76:77], v[80:81] op_sel:[1,1,0] op_sel_hi:[1,0,1] neg_lo:[0,1,0] neg_hi:[0,1,0]
    v_pk_mul_f32 v[82:83], v[76:77], v[76:77] op_sel:[0,0] op_sel_hi:[0,1]
    v_pk_fma_f32 v[76:77], v[76:77], v[76:77], v[82:83] op_sel:[1,1,0] op_sel_hi:[1,0,1] neg_lo:[0,1,0]
    v_cvt_pk_f16_f32 v91, v80, v81
    v_pk_mul_f32 v[80:81], v[30:31], v[76:77] op_sel:[0,0] op_sel_hi:[0,1] neg_hi:[1,0]
    v_pk_fma_f32 v[80:81], v[30:31], v[76:77], v[80:81] op_sel:[1,1,0] op_sel_hi:[1,0,1] neg_lo:[0,1,0] neg_hi:[0,1,0]
    v_pk_mul_f32 v[82:83], v[76:77], v[76:77] op_sel:[0,0] op_sel_hi:[0,1]
    v_pk_fma_f32 v[76:77], v[76:77], v[76:77], v[82:83] op_sel:[1,1,0] op_sel_hi:[1,0,1] neg_lo:[0,1,0]
    v_cvt_pk_f16_f32 v95, v80, v81
    v_pk_mul_f32 v[80:81], v[30:31], v[76:77] op_sel:[0,0] op_sel_hi:[0,1] neg_hi:[1,0]
    v_pk_fma_f32 v[80:81], v[30:31], v[76:77], v[80:81] op_sel:[1,1,0] op_sel_hi:[1,0,1] neg_lo:[0,1,0] neg_hi:[0,1,0]
    v_pk_mul_f32 v[82:83], v[76:77], v[76:77] op_sel:[0,0] op_sel_hi:[0,1]
    v_pk_fma_f32 v[76:77], v[76:77], v[76:77], v[82:83] op_sel:[1,1,0] op_sel_hi:[1,0,1] neg_lo:[0,1,0]
    v_cvt_pk_f16_f32 v99, v80, v81
    v_fma_f32 v64, v30, v76, v64
    v_fma_f32 v64, -v31, v77, v64
    s_cmp_eq_u32 s94, 0
    s_cbranch_scc1 L_beat6
    v_add_u32 v181, 1, v181
    global_store_dword v180, v181, s[6:7] sc0 sc1
L_beat6:
    v_mfma_f32_16x16x32_f16 v[48:51], v[84:87], v[100:103], v[48:51]
    v_mfma_f32_16x16x32_f16 v[52:55], v[88:91], v[104:107], v[52:55]
    v_mfma_f32_16x16x32_f16 v[56:59], v[92:95], v[108:111], v[56:59]
    v_mfma_f32_16x16x32_f16 v[60:63], v[96:99], v[112:115], v[60:63]
    s_waitcnt lgkmcnt(3)
    v_pk_mul_f32 v[66:67], v[32:33], v[10:11]
    v_fract_f32 v67, v67
    v_exp_f32 v70, v66
    v_cos_f32 v72, v67
    v_sin_f32 v73, v67
    s_nop 0
    v_pk_mul_f32 v[76:77], v[70:71], v[72:73] op_sel:[0,0] op_sel_hi:[0,1]
    v_cvt_pk_f16_f32 v100, v76, v77
    v_pk_mul_f32 v[82:83], v[76:77], v[76:77] op_sel:[0,0] op_sel_hi:[0,1]
    v_pk_fma_f32 v[76:77], v[76:77], v[76:77], v[82:83] op_sel:[1,1,0] op_sel_hi:[1,0,1] neg_lo:[0,1,0]
    v_cvt_pk_f16_f32 v104, v76, v77
    v_pk_mul_f32 v[82:83], v[76:77], v[76:77] op_sel:[0,0] op_sel_hi:[0,1]
    v_pk_fma_f32 v[76:77], v[76:77], v[76:77], v[82:83] op_sel:[1,1,0] op_sel_hi:[1,0,1] neg_lo:[0,1,0]
    v_cvt_pk_f16_f32 v108, v76, v77
    v_pk_mul_f32 v[82:83], v[76:77], v[76:77] op_sel:[0,0] op_sel_hi:[0,1]
    v_pk_fma_f32 v[76:77], v[76:77], v[76:77], v[82:83] op_sel:[1,1,0] op_sel_hi:[1,0,1] neg_lo:[0,1,0]
    v_cvt_pk_f16_f32 v112, v76, v77
    v_pk_mul_f32 v[82:83], v[76:77], v[76:77] op_sel:[0,0] op_sel_hi:[0,1]
    v_pk_fma_f32 v[76:77], v[76:77], v[76:77], v[82:83] op_sel:[1,1,0] op_sel_hi:[1,0,1] neg_lo:[0,1,0]
    v_pk_mul_f32 v[80:81], v[34:35], v[76:77] op_sel:[0,0] op_sel_hi:[0,1] neg_hi:[1,0]
    v_pk_fma_f32 v[80:81], v[34:35], v[76:77], v[80:81] op_sel:[1,1,0] op_sel_hi:[1,0,1] neg_lo:[0,1,0] neg_hi:[0,1,0]
    v_pk_mul_f32 v[82:83], v[76:77], v[76:77] op_sel:[0,0] op_sel_hi:[0,1]
    v_pk_fma_f32 v[76:77], v[76:77], v[76:77], v[82:83] op_sel:[1,1,0] op_sel_hi:[1,0,1] neg_lo:[0,1,0]
    v_cvt_pk_f16_f32 v84, v80, v81
    v_pk_mul_f32 v[80:81], v[34:35], v[76:77] op_sel:[0,0] op_sel_hi:[0,1] neg_hi:[1,0]
    v_pk_fma_f32 v[80:81], v[34:35], v[76:77], v[80:81] op_sel:[1,1,0] op_sel_hi:[1,0,1] neg_lo:[0,1,0] neg_hi:[0,1,0]
    v_pk_mul_f32 v[82:83], v[76:77], v[76:77] op_sel:[0,0] op_sel_hi:[0,1]
    v_pk_fma_f32 v[76:77], v[76:77], v[76:77], v[82:83] op_sel:[1,1,0] op_sel_hi:[1,0,1] neg_lo:[0,1,0]
    v_cvt_pk_f16_f32 v88, v80, v81
    v_pk_mul_f32 v[80:81], v[34:35], v[76:77] op_sel:[0,0] op_sel_hi:[0,1] neg_hi:[1,0]
    v_pk_fma_f32 v[80:81], v[34:35], v[76:77], v[80:81] op_sel:[1,1,0] op_sel_hi:[1,0,1] neg_lo:[0,1,0] neg_hi:[0,1,0]
    v_pk_mul_f32 v[82:83], v[76:77], v[76:77] op_sel:[0,0] op_sel_hi:[0,1]
    v_pk_fma_f32 v[76:77], v[76:77], v[76:77], v[82:83] op_sel:[1,1,0] op_sel_hi:[1,0,1] neg_lo:[0,1,0]
    v_cvt_pk_f16_f32 v92, v80, v81
    v_pk_mul_f32 v[80:81], v[34:35], v[76:77] op_sel:[0,0] op_sel_hi:[0,1] neg_hi:[1,0]
    v_pk_fma_f32 v[80:81], v[34:35], v[76:77], v[80:81] op_sel:[1,1,0] op_sel_hi:[1,0,1] neg_lo:[0,1,0] neg_hi:[0,1,0]
    v_pk_mul_f32 v[82:83], v[76:77], v[76:77] op_sel:[0,0] op_sel_hi:[0,1]
    v_pk_fma_f32 v[76:77], v[76:77], v[76:77], v[82:83] op_sel:[1,1,0] op_sel_hi:[1,0,1] neg_lo:[0,1,0]
    v_cvt_pk_f16_f32 v96, v80, v81
    v_fma_f32 v64, v34, v76, v64
    v_fma_f32 v64, -v35, v77, v64
    s_cmp_eq_u32 s94, 0
    s_cbranch_scc1 L_beat7
    v_add_u32 v181, 1, v181
    global_store_dword v180, v181, s[6:7] sc0 sc1
L_beat7:
    s_waitcnt lgkmcnt(2)
    v_pk_mul_f32 v[66:67], v[36:37], v[10:11]
    v_fract_f32 v67, v67
    v_exp_f32 v70, v66
    v_cos_f32 v72, v67
    v_sin_f32 v73, v67
    s_nop 0
    v_pk_mul_f32 v[76:77], v[70:71], v[72:73] op_sel:[0,0] op_sel_hi:[0,1]
    v_cvt_pk_f16_f32 v101, v76, v77
    v_pk_mul_f32 v[82:83], v[76:77], v[76:77] op_sel:[0,0] op_sel_hi:[0,1]
    v_pk_fma_f32 v[76:77], v[76:77], v[76:77], v[82:83] op_sel:[1,1,0] op_sel_hi:[1,0,1] neg_lo:[0,1,0]
    v_cvt_pk_f16_f32 v105, v76, v77
    v_pk_mul_f32 v[82:83], v[76:77], v[76:77] op_sel:[0,0] op_sel_hi:[0,1]
    v_pk_fma_f32 v[76:77], v[76:77], v[76:77], v[82:83] op_sel:[1,1,0] op_sel_hi:[1,0,1] neg_lo:[0,1,0]
    v_cvt_pk_f16_f32 v109, v76, v77
    v_pk_mul_f32 v[82:83], v[76:77], v[76:77] op_sel:[0,0] op_sel_hi:[0,1]
    v_pk_fma_f32 v[76:77], v[76:77], v[76:77], v[82:83] op_sel:[1,1,0] op_sel_hi:[1,0,1] neg_lo:[0,1,0]
    v_cvt_pk_f16_f32 v113, v76, v77
    v_pk_mul_f32 v[82:83], v[76:77], v[76:77] op_sel:[0,0] op_sel_hi:[0,1]
    v_pk_fma_f32 v[76:77], v[76:77], v[76:77], v[82:83] op_sel:[1,1,0] op_sel_hi:[1,0,1] neg_lo:[0,1,0]
    v_pk_mul_f32 v[80:81], v[38:39], v[76:77] op_sel:[0,0] op_sel_hi:[0,1] neg_hi:[1,0]
    v_pk_fma_f32 v[80:81], v[38:39], v[76:77], v[80:81] op_sel:[1,1,0] op_sel_hi:[1,0,1] neg_lo:[0,1,0] neg_hi:[0,1,0]
    v_pk_mul_f32 v[82:83], v[76:77], v[76:77] op_sel:[0,0] op_sel_hi:[0,1]
    v_pk_fma_f32 v[76:77], v[76:77], v[76:77], v[82:83] op_sel:[1,1,0] op_sel_hi:[1,0,1] neg_lo:[0,1,0]
    v_cvt_pk_f16_f32 v85, v80, v81
    v_pk_mul_f32 v[80:81], v[38:39], v[76:77] op_sel:[0,0] op_sel_hi:[0,1] neg_hi:[1,0]
    v_pk_fma_f32 v[80:81], v[38:39], v[76:77], v[80:81] op_sel:[1,1,0] op_sel_hi:[1,0,1] neg_lo:[0,1,0] neg_hi:[0,1,0]
    v_pk_mul_f32 v[82:83], v[76:77], v[76:77] op_sel:[0,0] op_sel_hi:[0,1]
    v_pk_fma_f32 v[76:77], v[76:77], v[76:77], v[82:83] op_sel:[1,1,0] op_sel_hi:[1,0,1] neg_lo:[0,1,0]
    v_cvt_pk_f16_f32 v89, v80, v81
    v_pk_mul_f32 v[80:81], v[38:39], v[76:77] op_sel:[0,0] op_sel_hi:[0,1] neg_hi:[1,0]
    v_pk_fma_f32 v[80:81], v[38:39], v[76:77], v[80:81] op_sel:[1,1,0] op_sel_hi:[1,0,1] neg_lo:[0,1,0] neg_hi:[0,1,0]
    v_pk_mul_f32 v[82:83], v[76:77], v[76:77] op_sel:[0,0] op_sel_hi:[0,1]
    v_pk_fma_f32 v[76:77], v[76:77], v[76:77], v[82:83] op_sel:[1,1,0] op_sel_hi:[1,0,1] neg_lo:[0,1,0]
    v_cvt_pk_f16_f32 v93, v80, v81
    v_pk_mul_f32 v[80:81], v[38:39], v[76:77] op_sel:[0,0] op_sel_hi:[0,1] neg_hi:[1,0]
    v_pk_fma_f32 v[80:81], v[38:39], v[76:77], v[80:81] op_sel:[1,1,0] op_sel_hi:[1,0,1] neg_lo:[0,1,0] neg_hi:[0,1,0]
    v_pk_mul_f32 v[82:83], v[76:77], v[76:77] op_sel:[0,0] op_sel_hi:[0,1]
    v_pk_fma_f32 v[76:77], v[76:77], v[76:77], v[82:83] op_sel:[1,1,0] op_sel_hi:[1,0,1] neg_lo:[0,1,0]
    v_cvt_pk_f16_f32 v97, v80, v81
    v_fma_f32 v64, v38, v76, v64
    v_fma_f32 v64, -v39, v77, v64
    s_cmp_eq_u32 s94, 0
    s_cbranch_scc1 L_beat8
    v_add_u32 v181, 1, v181
    global_store_dword v180, v181, s[6:7] sc0 sc1
L_beat8:
    global_load_dword v122, v121, s[6:7] sc0 sc1
    s_waitcnt lgkmcnt(1)
    v_pk_mul_f32 v[66:67], v[40:41], v[10:11]
    v_fract_f32 v67, v67
    v_exp_f32 v70, v66
    v_cos_f32 v72, v67
    v_sin_f32 v73, v67
    s_nop 0
    v_pk_mul_f32 v[76:77], v[70:71], v[72:73] op_sel:[0,0] op_sel_hi:[0,1]
    v_cvt_pk_f16_f32 v102, v76, v77
    v_pk_mul_f32 v[82:83], v[76:77], v[76:77] op_sel:[0,0] op_sel_hi:[0,1]
    v_pk_fma_f32 v[76:77], v[76:77], v[76:77], v[82:83] op_sel:[1,1,0] op_sel_hi:[1,0,1] neg_lo:[0,1,0]
    v_cvt_pk_f16_f32 v106, v76, v77
    v_pk_mul_f32 v[82:83], v[76:77], v[76:77] op_sel:[0,0] op_sel_hi:[0,1]
    v_pk_fma_f32 v[76:77], v[76:77], v[76:77], v[82:83] op_sel:[1,1,0] op_sel_hi:[1,0,1] neg_lo:[0,1,0]
    v_cvt_pk_f16_f32 v110, v76, v77
    v_pk_mul_f32 v[82:83], v[76:77], v[76:77] op_sel:[0,0] op_sel_hi:[0,1]
    v_pk_fma_f32 v[76:77], v[76:77], v[76:77], v[82:83] op_sel:[1,1,0] op_sel_hi:[1,0,1] neg_lo:[0,1,0]
    v_cvt_pk_f16_f32 v114, v76, v77
    v_pk_mul_f32 v[82:83], v[76:77], v[76:77] op_sel:[0,0] op_sel_hi:[0,1]
    v_pk_fma_f32 v[76:77], v[76:77], v[76:77], v[82:83] op_sel:[1,1,0] op_sel_hi:[1,0,1] neg_lo:[0,1,0]
    v_pk_mul_f32 v[80:81], v[42:43], v[76:77] op_sel:[0,0] op_sel_hi:[0,1] neg_hi:[1,0]
    v_pk_fma_f32 v[80:81], v[42:43], v[76:77], v[80:81] op_sel:[1,1,0] op_sel_hi:[1,0,1] neg_lo:[0,1,0] neg_hi:[0,1,0]
    v_pk_mul_f32 v[82:83], v[76:77], v[76:77] op_sel:[0,0] op_sel_hi:[0,1]
    v_pk_fma_f32 v[76:77], v[76:77], v[76:77], v[82:83] op_sel:[1,1,0] op_sel_hi:[1,0,1] neg_lo:[0,1,0]
    v_cvt_pk_f16_f32 v86, v80, v81
    v_pk_mul_f32 v[80:81], v[42:43], v[76:77] op_sel:[0,0] op_sel_hi:[0,1] neg_hi:[1,0]
    v_pk_fma_f32 v[80:81], v[42:43], v[76:77], v[80:81] op_sel:[1,1,0] op_sel_hi:[1,0,1] neg_lo:[0,1,0] neg_hi:[0,1,0]
    v_pk_mul_f32 v[82:83], v[76:77], v[76:77] op_sel:[0,0] op_sel_hi:[0,1]
    v_pk_fma_f32 v[76:77], v[76:77], v[76:77], v[82:83] op_sel:[1,1,0] op_sel_hi:[1,0,1] neg_lo:[0,1,0]
    v_cvt_pk_f16_f32 v90, v80, v81
    v_pk_mul_f32 v[80:81], v[42:43], v[76:77] op_sel:[0,0] op_sel_hi:[0,1] neg_hi:[1,0]
    v_pk_fma_f32 v[80:81], v[42:43], v[76:77], v[80:81] op_sel:[1,1,0] op_sel_hi:[1,0,1] neg_lo:[0,1,0] neg_hi:[0,1,0]
    v_pk_mul_f32 v[82:83], v[76:77], v[76:77] op_sel:[0,0] op_sel_hi:[0,1]
    v_pk_fma_f32 v[76:77], v[76:77], v[76:77], v[82:83] op_sel:[1,1,0] op_sel_hi:[1,0,1] neg_lo:[0,1,0]
    v_cvt_pk_f16_f32 v94, v80, v81
    v_pk_mul_f32 v[80:81], v[42:43], v[76:77] op_sel:[0,0] op_sel_hi:[0,1] neg_hi:[1,0]
    v_pk_fma_f32 v[80:81], v[42:43], v[76:77], v[80:81] op_sel:[1,1,0] op_sel_hi:[1,0,1] neg_lo:[0,1,0] neg_hi:[0,1,0]
    v_pk_mul_f32 v[82:83], v[76:77], v[76:77] op_sel:[0,0] op_sel_hi:[0,1]
    v_pk_fma_f32 v[76:77], v[76:77], v[76:77], v[82:83] op_sel:[1,1,0] op_sel_hi:[1,0,1] neg_lo:[0,1,0]
    v_cvt_pk_f16_f32 v98, v80, v81
    v_fma_f32 v64, v42, v76, v64
    v_fma_f32 v64, -v43, v77, v64
    s_cmp_eq_u32 s94, 0
    s_cbranch_scc1 L_beat9
    v_add_u32 v181, 1, v181
    global_store_dword v180, v181, s[6:7] sc0 sc1
L_beat9:
    s_waitcnt lgkmcnt(0)
    v_pk_mul_f32 v[66:67], v[44:45], v[10:11]
    v_fract_f32 v67, v67
    v_exp_f32 v70, v66
    v_cos_f32 v72, v67
    v_sin_f32 v73, v67
    s_nop 0
    v_pk_mul_f32 v[76:77], v[70:71], v[72:73] op_sel:[0,0] op_sel_hi:[0,1]
    v_cvt_pk_f16_f32 v103, v76, v77
    v_pk_mul_f32 v[82:83], v[76:77], v[76:77] op_sel:[0,0] op_sel_hi:[0,1]
    v_pk_fma_f32 v[76:77], v[76:77], v[76:77], v[82:83] op_sel:[1,1,0] op_sel_hi:[1,0,1] neg_lo:[0,1,0]
    v_cvt_pk_f16_f32 v107, v76, v77
    v_pk_mul_f32 v[82:83], v[76:77], v[76:77] op_sel:[0,0] op_sel_hi:[0,1]
    v_pk_fma_f32 v[76:77], v[76:77], v[76:77], v[82:83] op_sel:[1,1,0] op_sel_hi:[1,0,1] neg_lo:[0,1,0]
    v_cvt_pk_f16_f32 v111, v76, v77
    v_pk_mul_f32 v[82:83], v[76:77], v[76:77] op_sel:[0,0] op_sel_hi:[0,1]
    v_pk_fma_f32 v[76:77], v[76:77], v[76:77], v[82:83] op_sel:[1,1,0] op_sel_hi:[1,0,1] neg_lo:[0,1,0]
    v_cvt_pk_f16_f32 v115, v76, v77
    v_pk_mul_f32 v[82:83], v[76:77], v[76:77] op_sel:[0,0] op_sel_hi:[0,1]
    v_pk_fma_f32 v[76:77], v[76:77], v[76:77], v[82:83] op_sel:[1,1,0] op_sel_hi:[1,0,1] neg_lo:[0,1,0]
    v_pk_mul_f32 v[80:81], v[46:47], v[76:77] op_sel:[0,0] op_sel_hi:[0,1] neg_hi:[1,0]
    v_pk_fma_f32 v[80:81], v[46:47], v[76:77], v[80:81] op_sel:[1,1,0] op_sel_hi:[1,0,1] neg_lo:[0,1,0] neg_hi:[0,1,0]
    v_pk_mul_f32 v[82:83], v[76:77], v[76:77] op_sel:[0,0] op_sel_hi:[0,1]
    v_pk_fma_f32 v[76:77], v[76:77], v[76:77], v[82:83] op_sel:[1,1,0] op_sel_hi:[1,0,1] neg_lo:[0,1,0]
    v_cvt_pk_f16_f32 v87, v80, v81
    v_pk_mul_f32 v[80:81], v[46:47], v[76:77] op_sel:[0,0] op_sel_hi:[0,1] neg_hi:[1,0]
    v_pk_fma_f32 v[80:81], v[46:47], v[76:77], v[80:81] op_sel:[1,1,0] op_sel_hi:[1,0,1] neg_lo:[0,1,0] neg_hi:[0,1,0]
    v_pk_mul_f32 v[82:83], v[76:77], v[76:77] op_sel:[0,0] op_sel_hi:[0,1]
    v_pk_fma_f32 v[76:77], v[76:77], v[76:77], v[82:83] op_sel:[1,1,0] op_sel_hi:[1,0,1] neg_lo:[0,1,0]
    v_cvt_pk_f16_f32 v91, v80, v81
    v_pk_mul_f32 v[80:81], v[46:47], v[76:77] op_sel:[0,0] op_sel_hi:[0,1] neg_hi:[1,0]
    v_pk_fma_f32 v[80:81], v[46:47], v[76:77], v[80:81] op_sel:[1,1,0] op_sel_hi:[1,0,1] neg_lo:[0,1,0] neg_hi:[0,1,0]
    v_pk_mul_f32 v[82:83], v[76:77], v[76:77] op_sel:[0,0] op_sel_hi:[0,1]
    v_pk_fma_f32 v[76:77], v[76:77], v[76:77], v[82:83] op_sel:[1,1,0] op_sel_hi:[1,0,1] neg_lo:[0,1,0]
    v_cvt_pk_f16_f32 v95, v80, v81
    v_pk_mul_f32 v[80:81], v[46:47], v[76:77] op_sel:[0,0] op_sel_hi:[0,1] neg_hi:[1,0]
    v_pk_fma_f32 v[80:81], v[46:47], v[76:77], v[80:81] op_sel:[1,1,0] op_sel_hi:[1,0,1] neg_lo:[0,1,0] neg_hi:[0,1,0]
    v_pk_mul_f32 v[82:83], v[76:77], v[76:77] op_sel:[0,0] op_sel_hi:[0,1]
    v_pk_fma_f32 v[76:77], v[76:77], v[76:77], v[82:83] op_sel:[1,1,0] op_sel_hi:[1,0,1] neg_lo:[0,1,0]
    v_cvt_pk_f16_f32 v99, v80, v81
    v_fma_f32 v64, v46, v76, v64
    v_fma_f32 v64, -v47, v77, v64
    s_cmp_eq_u32 s94, 0
    s_cbranch_scc1 L_beat10
    v_add_u32 v181, 1, v181
    global_store_dword v180, v181, s[6:7] sc0 sc1
L_beat10:
    v_mfma_f32_16x16x32_f16 v[48:51], v[84:87], v[100:103], v[48:51]
    v_mfma_f32_16x16x32_f16 v[52:55], v[88:91], v[104:107], v[52:55]
    v_mfma_f32_16x16x32_f16 v[56:59], v[92:95], v[108:111], v[56:59]
    v_mfma_f32_16x16x32_f16 v[60:63], v[96:99], v[112:115], v[60:63]
    s_nop 4
    ds_write_b32 v154, v48 offset:0
    ds_write_b32 v154, v49 offset:256
    ds_write_b32 v154, v50 offset:512
    ds_write_b32 v154, v51 offset:768
    ds_write_b32 v154, v52 offset:1024
    ds_write_b32 v154, v53 offset:1280
    ds_write_b32 v154, v54 offset:1536
    ds_write_b32 v154, v55 offset:1792
    ds_write_b32 v154, v56 offset:2048
    ds_write_b32 v154, v57 offset:2304
    ds_write_b32 v154, v58 offset:2560
    ds_write_b32 v154, v59 offset:2816
    ds_write_b32 v154, v60 offset:3072
    ds_write_b32 v154, v61 offset:3328
    ds_write_b32 v154, v62 offset:3584
    ds_write_b32 v154, v63 offset:3840
    ds_write_b32 v155, v64 offset:22528
    s_waitcnt lgkmcnt(0)
    s_barrier
    ds_read_b32 v32, v157 offset:22560
    ds_read_b128 v[16:19], v158
    ds_read_b128 v[20:23], v158 offset:4096
    ds_read_b128 v[24:27], v158 offset:8192
    ds_read_b128 v[28:31], v158 offset:12288
    s_waitcnt lgkmcnt(0)
    v_add_f32 v16, v16, v20
    v_add_f32 v24, v24, v28
    v_add_f32 v17, v17, v21
    v_add_f32 v25, v25, v29
    v_add_f32 v18, v18, v22
    v_add_f32 v26, v26, v30
    v_add_f32 v19, v19, v23
    v_add_f32 v27, v27, v31
    v_add_f32 v16, v16, v24
    v_add_f32 v17, v17, v25
    v_add_f32 v18, v18, v26
    v_add_f32 v19, v19, v27
    v_add_f32_dpp v33, v32, v32 row_ror:8 row_mask:0xf bank_mask:0xf
    s_nop 1
    v_add_f32_dpp v32, v33, v33 row_ror:4 row_mask:0xf bank_mask:0xf
    s_nop 1
    v_add_f32_dpp v33, v32, v32 row_ror:2 row_mask:0xf bank_mask:0xf
    s_nop 1
    v_add_f32_dpp v32, v33, v33 row_ror:1 row_mask:0xf bank_mask:0xf
    ds_write_b128 v156, v[16:19] offset:16384
    v_mov_b32 v6, 0
    ds_write_b32 v6, v32 offset:20992
    s_waitcnt lgkmcnt(0)
    s_barrier
    ds_read_b32 v32, v146 offset:16384
    ds_read_b32 v33, v147 offset:16384
    ds_read_b32 v34, v148 offset:16384
    ds_read_b32 v35, v149 offset:16384
    ds_read_b32 v36, v150 offset:16384
    ds_read_b32 v37, v151 offset:16384
    ds_read_b32 v38, v152 offset:16384
    ds_read_b32 v39, v153 offset:16384
    s_waitcnt lgkmcnt(0)
    v_mul_f32 v32, 0x39800000, v32
    v_mul_f32 v33, 0x39800000, v33
    v_mul_f32 v34, 0x39800000, v34
    v_mul_f32 v35, 0x39800000, v35
    v_mul_f32 v36, 0x39800000, v36
    v_mul_f32 v37, 0x39800000, v37
    v_mul_f32 v38, 0x39800000, v38
    v_mul_f32 v39, 0x39800000, v39
    v_cvt_pk_bf16_f32 v124, v32, v33
    v_cvt_pk_bf16_f32 v125, v34, v35
    v_cvt_pk_bf16_f32 v126, v36, v37
    v_cvt_pk_bf16_f32 v127, v38, v39
    v_add_u32 v3, 77824, v158
    v_add_u32 v4, 77824, v159
    ds_write_b128 v3, v[124:127]
    s_cmp_lg_u32 s95, 0
    s_cbranch_scc1 L_B_hs_skip
    s_cmp_lg_u32 s14, 0
    s_cbranch_scc1 L_B_hs_skip
    s_cmp_eq_u32 s2, 511
    s_cbranch_scc1 L_B_hs_skip
    s_setprio 3
    s_waitcnt vmcnt(0)
    v_cmp_ne_u32 vcc, v122, v120
    s_cbranch_vccnz L_B_hs_ok
    s_mov_b32 s96, 0
L_B_hs:
    global_load_dword v122, v121, s[6:7] sc0 sc1
    s_waitcnt vmcnt(0)
    v_cmp_ne_u32 vcc, v122, v120
    s_cbranch_vccnz L_B_hs_ok
    s_add_u32 s96, s96, 1
    s_cmp_lt_u32 s96, 131072
    s_cbranch_scc0 L_B_hs_ok
    s_sleep 1
    s_branch L_B_hs
L_B_hs_ok:
    s_lshl_b32 s8, s2, 2
    s_add_u32 s8, s8, 0x2001000
    v_mov_b32 v5, s8
    v_mov_b32 v6, 1
    global_store_dword v5, v6, s[6:7] sc0 sc1
    s_setprio 2
L_B_hs_skip:
    s_waitcnt lgkmcnt(0)
    s_barrier
    ds_read_b128 v[128:131], v4 offset:16
    v_cmp_eq_u32 vcc, 255, v0
    s_waitcnt lgkmcnt(0)
    s_nop 0
    v_cndmask_b32 v128, v128, 0, vcc
    v_cndmask_b32 v129, v129, 0, vcc
    v_cndmask_b32 v130, v130, 0, vcc
    v_cndmask_b32 v131, v131, 0, vcc
    s_cmp_lg_u32 s95, 0
    s_cbranch_scc1 L_kg_done
    v_mov_b32 v132, v124
    v_mov_b32 v133, v125
    v_mov_b32 v134, v126
    v_mov_b32 v135, v127
    v_mov_b32 v136, v128
    v_mov_b32 v137, v129
    v_mov_b32 v138, v130
    v_mov_b32 v139, v131
    v_mov_b32 v5, v140
    v_mov_b32 v6, v141
    v_mov_b32 v7, v142
    v_mov_b32 v8, v143
    v_mov_b32 v9, v144
    s_mov_b32 s95, 1
    s_branch L_kg
L_kg_done:
    s_cmp_eq_u32 s94, 0
    s_cbranch_scc1 L_co_ok
    s_mov_b32 s96, 0
L_co:
    v_add_u32 v181, 1, v181
    global_store_dword v180, v181, s[6:7] sc0 sc1
    global_load_dwordx4 v[184:187], v182, s[6:7] sc0 sc1
    global_load_dwordx4 v[188:191], v182, s[6:7] offset:1024 sc0 sc1
    s_waitcnt vmcnt(0)
    v_and_b32 v184, v184, v185
    v_and_b32 v186, v186, v187
    v_and_b32 v188, v188, v189
    v_and_b32 v190, v190, v191
    v_and_b32 v184, v184, v186
    v_and_b32 v188, v188, v190
    v_and_b32 v184, v184, v188
    v_cmp_ne_u32 vcc, 1, v184
    s_cbranch_vccz L_co_ok
    s_add_u32 s96, s96, 1
    s_cmp_lt_u32 s96, 131072
    s_cbranch_scc1 L_co
L_co_ok:
    s_lshl_b32 s9, s3, 13
    s_add_u32 s9, s9, 0xa00000
    s_lshl_b32 s10, s3, 4
    s_add_u32 s10, s10, 0x200000
    v_lshlrev_b32 v3, 4, v0
    v_lshlrev_b32 v41, 13, v0
    v_add_u32 v41, s10, v41
    v_add_u32 v42, 0x1000, v41
    v_add_u32 v6, s9, v3
    v_add_u32 v43, 0x1000, v6
    v_mov_b32 v40, v145
    v_lshlrev_b32 v4, 4, v1
    v_add_u32 v4, 0x2000000, v4
    v_mov_b32 v44, 0
    v_mov_b32 v45, 0
    v_mov_b32 v46, 0
    v_mov_b32 v47, 0
    v_add_u32 v5, 38912, v3
    v_mul_u32_u24 v8, 4176, v0
    v_cmp_gt_u32 vcc, 8, v0
    s_and_saveexec_b64 s[12:13], vcc
    ds_write_b128 v8, v[44:47] offset:4096
    ds_write_b128 v8, v[44:47] offset:43008
    s_mov_b64 exec, s[12:13]
    v_cmp_gt_u32 vcc, 32, v0
    s_and_saveexec_b64 s[12:13], vcc
    ds_write_b128 v3, v[44:47] offset:33408
    ds_write_b128 v5, v[44:47] offset:33408
    s_mov_b64 exec, s[12:13]
    v_lshrrev_b32 v9, 4, v1
    v_and_b32 v10, 15, v1
    v_lshrrev_b32 v11, 3, v10
    v_and_b32 v12, 7, v10
    v_mul_u32_u24 v12, 4176, v12
    v_sub_u32 v13, v9, v11
    v_lshlrev_b32 v13, 4, v13
    v_add_u32 v12, v12, v13
    v_lshlrev_b32 v13, 7, v2
    v_sub_u32 v12, v12, v13
    v_add_u32 v12, 400, v12
    v_lshlrev_b32 v14, 5, v10
    v_lshl_add_u32 v14, v9, 4, v14
    v_sub_u32 v14, v14, v13
    v_add_u32 v14, 33824, v14
    v_lshlrev_b32 v15, 6, v10
    v_lshl_add_u32 v15, v9, 4, v15
    v_lshl_add_u32 v15, v2, 13, v15
    v_add_u32 v10, 38912, v12
    v_add_u32 v11, 38912, v14
    v_lshlrev_b32 v9, 5, v0
    v_mov_b32 v192, 0
    v_mov_b32 v193, 0
    v_mov_b32 v194, 0
    v_mov_b32 v195, 0
    v_mov_b32 v196, 0
    v_mov_b32 v197, 0
    v_mov_b32 v198, 0
    v_mov_b32 v199, 0
    v_mov_b32 v200, 0
    v_mov_b32 v201, 0
    v_mov_b32 v202, 0
    v_mov_b32 v203, 0
    v_mov_b32 v204, 0
    v_mov_b32 v205, 0
    v_mov_b32 v206, 0
    v_mov_b32 v207, 0
    v_mov_b32 v208, 0
    v_mov_b32 v209, 0
    v_mov_b32 v210, 0
    v_mov_b32 v211, 0
    v_mov_b32 v212, 0
    v_mov_b32 v213, 0
    v_mov_b32 v214, 0
    v_mov_b32 v215, 0
    v_mov_b32 v216, 0
    v_mov_b32 v217, 0
    v_mov_b32 v218, 0
    v_mov_b32 v219, 0
    v_mov_b32 v220, 0
    v_mov_b32 v221, 0
    v_mov_b32 v222, 0
    v_mov_b32 v223, 0
    v_mov_b32 v224, 0
    v_mov_b32 v225, 0
    v_mov_b32 v226, 0
    v_mov_b32 v227, 0
    v_mov_b32 v228, 0
    v_mov_b32 v229, 0
    v_mov_b32 v230, 0
    v_mov_b32 v231, 0
    v_mov_b32 v232, 0
    v_mov_b32 v233, 0
    v_mov_b32 v234, 0
    v_mov_b32 v235, 0
    v_mov_b32 v236, 0
    v_mov_b32 v237, 0
    v_mov_b32 v238, 0
    v_mov_b32 v239, 0
    v_mov_b32 v240, 0
    v_mov_b32 v241, 0
    v_mov_b32 v242, 0
    v_mov_b32 v243, 0
    v_mov_b32 v244, 0
    v_mov_b32 v245, 0
    v_mov_b32 v246, 0
    v_mov_b32 v247, 0
    v_mov_b32 v248, 0
    v_mov_b32 v249, 0
    v_mov_b32 v250, 0
    v_mov_b32 v251, 0
    v_mov_b32 v252, 0
    v_mov_b32 v253, 0
    v_mov_b32 v254, 0
    v_mov_b32 v255, 0
    v_alignbit_b32 v48, v133, v132, 16
    v_alignbit_b32 v54, v134, v133, 16
    v_mov_b32 v60, v133
    v_alignbit_b32 v49, v134, v133, 16
    v_alignbit_b32 v55, v135, v134, 16
    v_mov_b32 v61, v134
    v_alignbit_b32 v50, v135, v134, 16
    v_alignbit_b32 v56, v136, v135, 16
    v_mov_b32 v62, v135
    v_alignbit_b32 v51, v136, v135, 16
    v_alignbit_b32 v57, v137, v136, 16
    v_mov_b32 v63, v136
    v_alignbit_b32 v52, v137, v136, 16
    v_alignbit_b32 v58, v138, v137, 16
    v_mov_b32 v64, v137
    v_alignbit_b32 v53, v138, v137, 16
    v_alignbit_b32 v59, v139, v138, 16
    v_mov_b32 v65, v138
    ds_write_b128 v3, v[56:59] offset:0
    ds_write_b128 v3, v[62:65] offset:4176
    ds_write_b128 v3, v[50:53] offset:8352
    ds_write_b128 v3, v[134:137] offset:12528
    ds_write_b128 v3, v[54:57] offset:16704
    ds_write_b128 v3, v[60:63] offset:20880
    ds_write_b128 v3, v[48:51] offset:25056
    ds_write_b128 v3, v[132:135] offset:29232
    v_alignbit_b32 v66, v125, v124, 16
    v_alignbit_b32 v72, v126, v125, 16
    v_mov_b32 v78, v125
    v_alignbit_b32 v67, v126, v125, 16
    v_alignbit_b32 v73, v127, v126, 16
    v_mov_b32 v79, v126
    v_alignbit_b32 v68, v127, v126, 16
    v_alignbit_b32 v74, v128, v127, 16
    v_mov_b32 v80, v127
    v_alignbit_b32 v69, v128, v127, 16
    v_alignbit_b32 v75, v129, v128, 16
    v_mov_b32 v81, v128
    v_alignbit_b32 v70, v129, v128, 16
    v_alignbit_b32 v76, v130, v129, 16
    v_mov_b32 v82, v129
    v_alignbit_b32 v71, v130, v129, 16
    v_alignbit_b32 v77, v131, v130, 16
    v_mov_b32 v83, v130
    ds_write_b128 v5, v[74:77] offset:0
    ds_write_b128 v5, v[80:83] offset:4176
    ds_write_b128 v5, v[68:71] offset:8352
    ds_write_b128 v5, v[126:129] offset:12528
    ds_write_b128 v5, v[72:75] offset:16704
    ds_write_b128 v5, v[78:81] offset:20880
    ds_write_b128 v5, v[66:69] offset:25056
    ds_write_b128 v5, v[124:127] offset:29232
    s_setprio 3
    s_mov_b32 s96, 0
L_B_poll:
    global_load_dwordx4 v[16:19], v4, s[6:7] sc0 sc1
    s_waitcnt vmcnt(0)
    v_and_b32 v16, v16, v17
    v_and_b32 v18, v18, v19
    v_and_b32 v16, v16, v18
    v_cmp_ne_u32 vcc, 1, v16
    s_cbranch_vccz L_B_poll_ok
    s_add_u32 s96, s96, 1
    s_cmp_lt_u32 s96, 131072
    s_cbranch_scc0 L_B_poll_ok
    s_sleep 2
    s_branch L_B_poll
L_B_poll_ok:
    global_load_dwordx4 v[24:27], v41, s[6:7]
    global_load_dwordx4 v[36:39], v42, s[6:7]
    s_setprio 0
    s_waitcnt vmcnt(0)
    v_mov_b32 v28, v26
    v_mov_b32 v29, v27
    v_mov_b32 v26, v36
    v_mov_b32 v27, v37
    v_mov_b32 v36, v28
    v_mov_b32 v37, v29
    ds_write_b128 v3, v[24:27] offset:33920
    ds_write_b128 v5, v[36:39] offset:33920
    s_waitcnt lgkmcnt(0)
    s_barrier
    ds_read_b128 v[64:67], v12 offset:3648
    ds_read_b128 v[96:99], v14 offset:64
    ds_read_b128 v[68:71], v12 offset:3136
    ds_read_b128 v[100:103], v14 offset:576
    ds_read_b128 v[72:75], v12 offset:2624
    ds_read_b128 v[104:107], v14 offset:1088
    ds_read_b128 v[76:79], v12 offset:2112
    ds_read_b128 v[108:111], v14 offset:1600
    ds_read_b128 v[80:83], v12 offset:1600
    ds_read_b128 v[112:115], v14 offset:2112
    ds_read_b128 v[84:87], v12 offset:1088
    ds_read_b128 v[116:119], v14 offset:2624
    ds_read_b128 v[88:91], v12 offset:576
    ds_read_b128 v[120:123], v14 offset:3136
    ds_read_b128 v[92:95], v12 offset:64
    ds_read_b128 v[124:127], v14 offset:3648
    s_waitcnt lgkmcnt(0)
    ds_read_b128 v[128:131], v12 offset:3584
    ds_read_b128 v[160:163], v14 offset:0
    ds_read_b128 v[132:135], v12 offset:3072
    ds_read_b128 v[164:167], v14 offset:512
    ds_read_b128 v[136:139], v12 offset:2560
    ds_read_b128 v[168:171], v14 offset:1024
    ds_read_b128 v[140:143], v12 offset:2048
    ds_read_b128 v[172:175], v14 offset:1536
    ds_read_b128 v[144:147], v12 offset:1536
    ds_read_b128 v[176:179], v14 offset:2048
    ds_read_b128 v[148:151], v12 offset:1024
    ds_read_b128 v[180:183], v14 offset:2560
    ds_read_b128 v[152:155], v12 offset:512
    ds_read_b128 v[184:187], v14 offset:3072
    ds_read_b128 v[156:159], v12 offset:0
    ds_read_b128 v[188:191], v14 offset:3584
    v_mfma_f32_16x16x32_bf16 v[192:195], v[64:67], v[96:99], v[192:195]
    v_mfma_f32_16x16x32_bf16 v[196:199], v[64:67], v[100:103], v[196:199]
    v_mfma_f32_16x16x32_bf16 v[200:203], v[64:67], v[104:107], v[200:203]
    v_mfma_f32_16x16x32_bf16 v[204:207], v[64:67], v[108:111], v[204:207]
    v_mfma_f32_16x16x32_bf16 v[208:211], v[64:67], v[112:115], v[208:211]
    v_mfma_f32_16x16x32_bf16 v[212:215], v[64:67], v[116:119], v[212:215]
    v_mfma_f32_16x16x32_bf16 v[216:219], v[64:67], v[120:123], v[216:219]
    v_mfma_f32_16x16x32_bf16 v[220:223], v[64:67], v[124:127], v[220:223]
    v_mfma_f32_16x16x32_bf16 v[196:199], v[68:71], v[96:99], v[196:199]
    v_mfma_f32_16x16x32_bf16 v[200:203], v[68:71], v[100:103], v[200:203]
    v_mfma_f32_16x16x32_bf16 v[204:207], v[68:71], v[104:107], v[204:207]
    v_mfma_f32_16x16x32_bf16 v[208:211], v[68:71], v[108:111], v[208:211]
    v_mfma_f32_16x16x32_bf16 v[212:215], v[68:71], v[112:115], v[212:215]
    v_mfma_f32_16x16x32_bf16 v[216:219], v[68:71], v[116:119], v[216:219]
    v_mfma_f32_16x16x32_bf16 v[220:223], v[68:71], v[120:123], v[220:223]
    v_mfma_f32_16x16x32_bf16 v[200:203], v[72:75], v[96:99], v[200:203]
    v_mfma_f32_16x16x32_bf16 v[204:207], v[72:75], v[100:103], v[204:207]
    v_mfma_f32_16x16x32_bf16 v[208:211], v[72:75], v[104:107], v[208:211]
    v_mfma_f32_16x16x32_bf16 v[212:215], v[72:75], v[108:111], v[212:215]
    v_mfma_f32_16x16x32_bf16 v[216:219], v[72:75], v[112:115], v[216:219]
    v_mfma_f32_16x16x32_bf16 v[220:223], v[72:75], v[116:119], v[220:223]
    v_mfma_f32_16x16x32_bf16 v[204:207], v[76:79], v[96:99], v[204:207]
    v_mfma_f32_16x16x32_bf16 v[208:211], v[76:79], v[100:103], v[208:211]
    v_mfma_f32_16x16x32_bf16 v[212:215], v[76:79], v[104:107], v[212:215]
    v_mfma_f32_16x16x32_bf16 v[216:219], v[76:79], v[108:111], v[216:219]
    v_mfma_f32_16x16x32_bf16 v[220:223], v[76:79], v[112:115], v[220:223]
    v_mfma_f32_16x16x32_bf16 v[208:211], v[80:83], v[96:99], v[208:211]
    v_mfma_f32_16x16x32_bf16 v[212:215], v[80:83], v[100:103], v[212:215]
    v_mfma_f32_16x16x32_bf16 v[216:219], v[80:83], v[104:107], v[216:219]
    v_mfma_f32_16x16x32_bf16 v[220:223], v[80:83], v[108:111], v[220:223]
    v_mfma_f32_16x16x32_bf16 v[212:215], v[84:87], v[96:99], v[212:215]
    v_mfma_f32_16x16x32_bf16 v[216:219], v[84:87], v[100:103], v[216:219]
    v_mfma_f32_16x16x32_bf16 v[220:223], v[84:87], v[104:107], v[220:223]
    v_mfma_f32_16x16x32_bf16 v[216:219], v[88:91], v[96:99], v[216:219]
    v_mfma_f32_16x16x32_bf16 v[220:223], v[88:91], v[100:103], v[220:223]
    v_mfma_f32_16x16x32_bf16 v[220:223], v[92:95], v[96:99], v[220:223]
    s_waitcnt lgkmcnt(0)
    ds_read_b128 v[64:67], v10 offset:3648
    ds_read_b128 v[96:99], v11 offset:64
    ds_read_b128 v[68:71], v10 offset:3136
    ds_read_b128 v[100:103], v11 offset:576
    ds_read_b128 v[72:75], v10 offset:2624
    ds_read_b128 v[104:107], v11 offset:1088
    ds_read_b128 v[76:79], v10 offset:2112
    ds_read_b128 v[108:111], v11 offset:1600
    ds_read_b128 v[80:83], v10 offset:1600
    ds_read_b128 v[112:115], v11 offset:2112
    ds_read_b128 v[84:87], v10 offset:1088
    ds_read_b128 v[116:119], v11 offset:2624
    ds_read_b128 v[88:91], v10 offset:576
    ds_read_b128 v[120:123], v11 offset:3136
    ds_read_b128 v[92:95], v10 offset:64
    ds_read_b128 v[124:127], v11 offset:3648
    v_mfma_f32_16x16x32_bf16 v[192:195], v[128:131], v[160:163], v[192:195]
    v_mfma_f32_16x16x32_bf16 v[196:199], v[128:131], v[164:167], v[196:199]
    v_mfma_f32_16x16x32_bf16 v[200:203], v[128:131], v[168:171], v[200:203]
    v_mfma_f32_16x16x32_bf16 v[204:207], v[128:131], v[172:175], v[204:207]
    v_mfma_f32_16x16x32_bf16 v[208:211], v[128:131], v[176:179], v[208:211]
    v_mfma_f32_16x16x32_bf16 v[212:215], v[128:131], v[180:183], v[212:215]
    v_mfma_f32_16x16x32_bf16 v[216:219], v[128:131], v[184:187], v[216:219]
    v_mfma_f32_16x16x32_bf16 v[220:223], v[128:131], v[188:191], v[220:223]
    v_mfma_f32_16x16x32_bf16 v[196:199], v[132:135], v[160:163], v[196:199]
    v_mfma_f32_16x16x32_bf16 v[200:203], v[132:135], v[164:167], v[200:203]
    v_mfma_f32_16x16x32_bf16 v[204:207], v[132:135], v[168:171], v[204:207]
    v_mfma_f32_16x16x32_bf16 v[208:211], v[132:135], v[172:175], v[208:211]
    v_mfma_f32_16x16x32_bf16 v[212:215], v[132:135], v[176:179], v[212:215]
    v_mfma_f32_16x16x32_bf16 v[216:219], v[132:135], v[180:183], v[216:219]
    v_mfma_f32_16x16x32_bf16 v[220:223], v[132:135], v[184:187], v[220:223]
    v_mfma_f32_16x16x32_bf16 v[200:203], v[136:139], v[160:163], v[200:203]
    v_mfma_f32_16x16x32_bf16 v[204:207], v[136:139], v[164:167], v[204:207]
    v_mfma_f32_16x16x32_bf16 v[208:211], v[136:139], v[168:171], v[208:211]
    v_mfma_f32_16x16x32_bf16 v[212:215], v[136:139], v[172:175], v[212:215]
    v_mfma_f32_16x16x32_bf16 v[216:219], v[136:139], v[176:179], v[216:219]
    v_mfma_f32_16x16x32_bf16 v[220:223], v[136:139], v[180:183], v[220:223]
    v_mfma_f32_16x16x32_bf16 v[204:207], v[140:143], v[160:163], v[204:207]
    v_mfma_f32_16x16x32_bf16 v[208:211], v[140:143], v[164:167], v[208:211]
    v_mfma_f32_16x16x32_bf16 v[212:215], v[140:143], v[168:171], v[212:215]
    v_mfma_f32_16x16x32_bf16 v[216:219], v[140:143], v[172:175], v[216:219]
    v_mfma_f32_16x16x32_bf16 v[220:223], v[140:143], v[176:179], v[220:223]
    v_mfma_f32_16x16x32_bf16 v[208:211], v[144:147], v[160:163], v[208:211]
    v_mfma_f32_16x16x32_bf16 v[212:215], v[144:147], v[164:167], v[212:215]
    v_mfma_f32_16x16x32_bf16 v[216:219], v[144:147], v[168:171], v[216:219]
    v_mfma_f32_16x16x32_bf16 v[220:223], v[144:147], v[172:175], v[220:223]
    v_mfma_f32_16x16x32_bf16 v[212:215], v[148:151], v[160:163], v[212:215]
    v_mfma_f32_16x16x32_bf16 v[216:219], v[148:151], v[164:167], v[216:219]
    v_mfma_f32_16x16x32_bf16 v[220:223], v[148:151], v[168:171], v[220:223]
    v_mfma_f32_16x16x32_bf16 v[216:219], v[152:155], v[160:163], v[216:219]
    v_mfma_f32_16x16x32_bf16 v[220:223], v[152:155], v[164:167], v[220:223]
    v_mfma_f32_16x16x32_bf16 v[220:223], v[156:159], v[160:163], v[220:223]
    s_waitcnt lgkmcnt(0)
    ds_read_b128 v[128:131], v10 offset:3584
    ds_read_b128 v[160:163], v11 offset:0
    ds_read_b128 v[132:135], v10 offset:3072
    ds_read_b128 v[164:167], v11 offset:512
    ds_read_b128 v[136:139], v10 offset:2560
    ds_read_b128 v[168:171], v11 offset:1024
    ds_read_b128 v[140:143], v10 offset:2048
    ds_read_b128 v[172:175], v11 offset:1536
    ds_read_b128 v[144:147], v10 offset:1536
    ds_read_b128 v[176:179], v11 offset:2048
    ds_read_b128 v[148:151], v10 offset:1024
    ds_read_b128 v[180:183], v11 offset:2560
    ds_read_b128 v[152:155], v10 offset:512
    ds_read_b128 v[184:187], v11 offset:3072
    ds_read_b128 v[156:159], v10 offset:0
    ds_read_b128 v[188:191], v11 offset:3584
    v_mfma_f32_16x16x32_bf16 v[224:227], v[64:67], v[96:99], v[224:227]
    v_mfma_f32_16x16x32_bf16 v[228:231], v[64:67], v[100:103], v[228:231]
    v_mfma_f32_16x16x32_bf16 v[232:235], v[64:67], v[104:107], v[232:235]
    v_mfma_f32_16x16x32_bf16 v[236:239], v[64:67], v[108:111], v[236:239]
    v_mfma_f32_16x16x32_bf16 v[240:243], v[64:67], v[112:115], v[240:243]
    v_mfma_f32_16x16x32_bf16 v[244:247], v[64:67], v[116:119], v[244:247]
    v_mfma_f32_16x16x32_bf16 v[248:251], v[64:67], v[120:123], v[248:251]
    v_mfma_f32_16x16x32_bf16 v[252:255], v[64:67], v[124:127], v[252:255]
    v_mfma_f32_16x16x32_bf16 v[228:231], v[68:71], v[96:99], v[228:231]
    v_mfma_f32_16x16x32_bf16 v[232:235], v[68:71], v[100:103], v[232:235]
    v_mfma_f32_16x16x32_bf16 v[236:239], v[68:71], v[104:107], v[236:239]
    v_mfma_f32_16x16x32_bf16 v[240:243], v[68:71], v[108:111], v[240:243]
    v_mfma_f32_16x16x32_bf16 v[244:247], v[68:71], v[112:115], v[244:247]
    v_mfma_f32_16x16x32_bf16 v[248:251], v[68:71], v[116:119], v[248:251]
    v_mfma_f32_16x16x32_bf16 v[252:255], v[68:71], v[120:123], v[252:255]
    v_mfma_f32_16x16x32_bf16 v[232:235], v[72:75], v[96:99], v[232:235]
    v_mfma_f32_16x16x32_bf16 v[236:239], v[72:75], v[100:103], v[236:239]
    v_mfma_f32_16x16x32_bf16 v[240:243], v[72:75], v[104:107], v[240:243]
    v_mfma_f32_16x16x32_bf16 v[244:247], v[72:75], v[108:111], v[244:247]
    v_mfma_f32_16x16x32_bf16 v[248:251], v[72:75], v[112:115], v[248:251]
    v_mfma_f32_16x16x32_bf16 v[252:255], v[72:75], v[116:119], v[252:255]
    v_mfma_f32_16x16x32_bf16 v[236:239], v[76:79], v[96:99], v[236:239]
    v_mfma_f32_16x16x32_bf16 v[240:243], v[76:79], v[100:103], v[240:243]
    v_mfma_f32_16x16x32_bf16 v[244:247], v[76:79], v[104:107], v[244:247]
    v_mfma_f32_16x16x32_bf16 v[248:251], v[76:79], v[108:111], v[248:251]
    v_mfma_f32_16x16x32_bf16 v[252:255], v[76:79], v[112:115], v[252:255]
    v_mfma_f32_16x16x32_bf16 v[240:243], v[80:83], v[96:99], v[240:243]
    v_mfma_f32_16x16x32_bf16 v[244:247], v[80:83], v[100:103], v[244:247]
    v_mfma_f32_16x16x32_bf16 v[248:251], v[80:83], v[104:107], v[248:251]
    v_mfma_f32_16x16x32_bf16 v[252:255], v[80:83], v[108:111], v[252:255]
    v_mfma_f32_16x16x32_bf16 v[244:247], v[84:87], v[96:99], v[244:247]
    v_mfma_f32_16x16x32_bf16 v[248:251], v[84:87], v[100:103], v[248:251]
    v_mfma_f32_16x16x32_bf16 v[252:255], v[84:87], v[104:107], v[252:255]
    v_mfma_f32_16x16x32_bf16 v[248:251], v[88:91], v[96:99], v[248:251]
    v_mfma_f32_16x16x32_bf16 v[252:255], v[88:91], v[100:103], v[252:255]
    v_mfma_f32_16x16x32_bf16 v[252:255], v[92:95], v[96:99], v[252:255]
    s_waitcnt lgkmcnt(0)
    s_barrier
    v_mfma_f32_16x16x32_bf16 v[224:227], v[128:131], v[160:163], v[224:227]
    v_mfma_f32_16x16x32_bf16 v[228:231], v[128:131], v[164:167], v[228:231]
    v_mfma_f32_16x16x32_bf16 v[232:235], v[128:131], v[168:171], v[232:235]
    v_mfma_f32_16x16x32_bf16 v[236:239], v[128:131], v[172:175], v[236:239]
    v_mfma_f32_16x16x32_bf16 v[240:243], v[128:131], v[176:179], v[240:243]
    v_mfma_f32_16x16x32_bf16 v[244:247], v[128:131], v[180:183], v[244:247]
    v_mfma_f32_16x16x32_bf16 v[248:251], v[128:131], v[184:187], v[248:251]
    v_mfma_f32_16x16x32_bf16 v[252:255], v[128:131], v[188:191], v[252:255]
    v_mfma_f32_16x16x32_bf16 v[228:231], v[132:135], v[160:163], v[228:231]
    v_mfma_f32_16x16x32_bf16 v[232:235], v[132:135], v[164:167], v[232:235]
    v_mfma_f32_16x16x32_bf16 v[236:239], v[132:135], v[168:171], v[236:239]
    v_mfma_f32_16x16x32_bf16 v[240:243], v[132:135], v[172:175], v[240:243]
    v_mfma_f32_16x16x32_bf16 v[244:247], v[132:135], v[176:179], v[244:247]
    v_mfma_f32_16x16x32_bf16 v[248:251], v[132:135], v[180:183], v[248:251]
    v_mfma_f32_16x16x32_bf16 v[252:255], v[132:135], v[184:187], v[252:255]
    v_mfma_f32_16x16x32_bf16 v[232:235], v[136:139], v[160:163], v[232:235]
    v_mfma_f32_16x16x32_bf16 v[236:239], v[136:139], v[164:167], v[236:239]
    v_mfma_f32_16x16x32_bf16 v[240:243], v[136:139], v[168:171], v[240:243]
    v_mfma_f32_16x16x32_bf16 v[244:247], v[136:139], v[172:175], v[244:247]
    v_mfma_f32_16x16x32_bf16 v[248:251], v[136:139], v[176:179], v[248:251]
    v_mfma_f32_16x16x32_bf16 v[252:255], v[136:139], v[180:183], v[252:255]
    v_mfma_f32_16x16x32_bf16 v[236:239], v[140:143], v[160:163], v[236:239]
    v_mfma_f32_16x16x32_bf16 v[240:243], v[140:143], v[164:167], v[240:243]
    v_mfma_f32_16x16x32_bf16 v[244:247], v[140:143], v[168:171], v[244:247]
    v_mfma_f32_16x16x32_bf16 v[248:251], v[140:143], v[172:175], v[248:251]
    v_mfma_f32_16x16x32_bf16 v[252:255], v[140:143], v[176:179], v[252:255]
    v_mfma_f32_16x16x32_bf16 v[240:243], v[144:147], v[160:163], v[240:243]
    v_mfma_f32_16x16x32_bf16 v[244:247], v[144:147], v[164:167], v[244:247]
    v_mfma_f32_16x16x32_bf16 v[248:251], v[144:147], v[168:171], v[248:251]
    v_mfma_f32_16x16x32_bf16 v[252:255], v[144:147], v[172:175], v[252:255]
    v_mfma_f32_16x16x32_bf16 v[244:247], v[148:151], v[160:163], v[244:247]
    v_mfma_f32_16x16x32_bf16 v[248:251], v[148:151], v[164:167], v[248:251]
    v_mfma_f32_16x16x32_bf16 v[252:255], v[148:151], v[168:171], v[252:255]
    v_mfma_f32_16x16x32_bf16 v[248:251], v[152:155], v[160:163], v[248:251]
    v_mfma_f32_16x16x32_bf16 v[252:255], v[152:155], v[164:167], v[252:255]
    v_mfma_f32_16x16x32_bf16 v[252:255], v[156:159], v[160:163], v[252:255]
    v_add_u32 v13, 38912, v15
    ds_write_b128 v15, v[192:195] offset:0
    ds_write_b128 v15, v[196:199] offset:1024
    ds_write_b128 v15, v[200:203] offset:2048
    ds_write_b128 v15, v[204:207] offset:3072
    ds_write_b128 v15, v[208:211] offset:4096
    ds_write_b128 v15, v[212:215] offset:5120
    ds_write_b128 v15, v[216:219] offset:6144
    ds_write_b128 v15, v[220:223] offset:7168
    ds_write_b128 v13, v[224:227] offset:0
    ds_write_b128 v13, v[228:231] offset:1024
    ds_write_b128 v13, v[232:235] offset:2048
    ds_write_b128 v13, v[236:239] offset:3072
    ds_write_b128 v13, v[240:243] offset:4096
    ds_write_b128 v13, v[244:247] offset:5120
    ds_write_b128 v13, v[248:251] offset:6144
    ds_write_b128 v13, v[252:255] offset:7168
    v_add_u32 v13, 38912, v9
    v_and_b32 v41, 0xffff0000, v40
    v_lshlrev_b32 v40, 16, v40
    s_waitcnt lgkmcnt(0)
    s_barrier
    ds_read_b128 v[64:67], v9 offset:0
    ds_read_b128 v[68:71], v9 offset:16
    ds_read_b128 v[72:75], v9 offset:8192
    ds_read_b128 v[76:79], v9 offset:8208
    ds_read_b128 v[80:83], v9 offset:16384
    ds_read_b128 v[84:87], v9 offset:16400
    ds_read_b128 v[88:91], v9 offset:24576
    ds_read_b128 v[92:95], v9 offset:24592
    ds_read_b128 v[96:99], v13 offset:0
    ds_read_b128 v[100:103], v13 offset:16
    ds_read_b128 v[104:107], v13 offset:8192
    ds_read_b128 v[108:111], v13 offset:8208
    ds_read_b128 v[112:115], v13 offset:16384
    ds_read_b128 v[116:119], v13 offset:16400
    ds_read_b128 v[120:123], v13 offset:24576
    ds_read_b128 v[124:127], v13 offset:24592
    s_setprio 3
    v_lshlrev_b32 v128, 16, v24
    v_and_b32 v129, 0xffff0000, v24
    v_lshlrev_b32 v130, 16, v25
    v_and_b32 v131, 0xffff0000, v25
    v_lshlrev_b32 v132, 16, v26
    v_and_b32 v133, 0xffff0000, v26
    v_lshlrev_b32 v134, 16, v27
    v_and_b32 v135, 0xffff0000, v27
    v_mul_f32 v128, v128, v40
    v_mul_f32 v129, v129, v40
    v_mul_f32 v130, v130, v40
    v_mul_f32 v131, v131, v40
    v_mul_f32 v132, v132, v40
    v_mul_f32 v133, v133, v40
    v_mul_f32 v134, v134, v40
    v_mul_f32 v135, v135, v40
    v_cvt_pk_bf16_f32 v136, v128, v129
    v_cvt_pk_bf16_f32 v137, v130, v131
    v_cvt_pk_bf16_f32 v138, v132, v133
    v_cvt_pk_bf16_f32 v139, v134, v135
    v_lshlrev_b32 v128, 16, v136
    v_and_b32 v129, 0xffff0000, v136
    v_lshlrev_b32 v130, 16, v137
    v_and_b32 v131, 0xffff0000, v137
    v_lshlrev_b32 v132, 16, v138
    v_and_b32 v133, 0xffff0000, v138
    v_lshlrev_b32 v134, 16, v139
    v_and_b32 v135, 0xffff0000, v139
    v_lshlrev_b32 v144, 16, v36
    v_and_b32 v145, 0xffff0000, v36
    v_lshlrev_b32 v146, 16, v37
    v_and_b32 v147, 0xffff0000, v37
    v_lshlrev_b32 v148, 16, v38
    v_and_b32 v149, 0xffff0000, v38
    v_lshlrev_b32 v150, 16, v39
    v_and_b32 v151, 0xffff0000, v39
    v_mul_f32 v144, v144, v41
    v_mul_f32 v145, v145, v41
    v_mul_f32 v146, v146, v41
    v_mul_f32 v147, v147, v41
    v_mul_f32 v148, v148, v41
    v_mul_f32 v149, v149, v41
    v_mul_f32 v150, v150, v41
    v_mul_f32 v151, v151, v41
    v_cvt_pk_bf16_f32 v152, v144, v145
    v_cvt_pk_bf16_f32 v153, v146, v147
    v_cvt_pk_bf16_f32 v154, v148, v149
    v_cvt_pk_bf16_f32 v155, v150, v151
    v_lshlrev_b32 v144, 16, v152
    v_and_b32 v145, 0xffff0000, v152
    v_lshlrev_b32 v146, 16, v153
    v_and_b32 v147, 0xffff0000, v153
    v_lshlrev_b32 v148, 16, v154
    v_and_b32 v149, 0xffff0000, v154
    v_lshlrev_b32 v150, 16, v155
    v_and_b32 v151, 0xffff0000, v155
    s_waitcnt lgkmcnt(8)
    v_add_f32 v64, v64, v72
    v_add_f32 v80, v80, v88
    v_add_f32 v65, v65, v73
    v_add_f32 v81, v81, v89
    v_add_f32 v66, v66, v74
    v_add_f32 v82, v82, v90
    v_add_f32 v67, v67, v75
    v_add_f32 v83, v83, v91
    v_add_f32 v68, v68, v76
    v_add_f32 v84, v84, v92
    v_add_f32 v69, v69, v77
    v_add_f32 v85, v85, v93
    v_add_f32 v70, v70, v78
    v_add_f32 v86, v86, v94
    v_add_f32 v71, v71, v79
    v_add_f32 v87, v87, v95
    v_add_f32 v64, v64, v80
    v_add_f32 v65, v65, v81
    v_add_f32 v66, v66, v82
    v_add_f32 v67, v67, v83
    v_add_f32 v68, v68, v84
    v_add_f32 v69, v69, v85
    v_add_f32 v70, v70, v86
    v_add_f32 v71, v71, v87
    v_cvt_pk_bf16_f32 v136, v64, v65
    v_cvt_pk_bf16_f32 v137, v66, v67
    v_cvt_pk_bf16_f32 v138, v68, v69
    v_cvt_pk_bf16_f32 v139, v70, v71
    v_lshlrev_b32 v64, 16, v136
    v_and_b32 v65, 0xffff0000, v136
    v_lshlrev_b32 v66, 16, v137
    v_and_b32 v67, 0xffff0000, v137
    v_lshlrev_b32 v68, 16, v138
    v_and_b32 v69, 0xffff0000, v138
    v_lshlrev_b32 v70, 16, v139
    v_and_b32 v71, 0xffff0000, v139
    v_add_f32 v64, v64, v128
    v_add_f32 v65, v65, v129
    v_add_f32 v66, v66, v130
    v_add_f32 v67, v67, v131
    v_add_f32 v68, v68, v132
    v_add_f32 v69, v69, v133
    v_add_f32 v70, v70, v134
    v_add_f32 v71, v71, v135
    v_cvt_pk_bf16_f32 v136, v64, v65
    v_cvt_pk_bf16_f32 v137, v66, v67
    v_cvt_pk_bf16_f32 v138, v68, v69
    v_cvt_pk_bf16_f32 v139, v70, v71
    global_store_dwordx4 v6, v[136:139], s[6:7] sc0 sc1
    s_waitcnt lgkmcnt(0)
    v_add_f32 v96, v96, v104
    v_add_f32 v112, v112, v120
    v_add_f32 v97, v97, v105
    v_add_f32 v113, v113, v121
    v_add_f32 v98, v98, v106
    v_add_f32 v114, v114, v122
    v_add_f32 v99, v99, v107
    v_add_f32 v115, v115, v123
    v_add_f32 v100, v100, v108
    v_add_f32 v116, v116, v124
    v_add_f32 v101, v101, v109
    v_add_f32 v117, v117, v125
    v_add_f32 v102, v102, v110
    v_add_f32 v118, v118, v126
    v_add_f32 v103, v103, v111
    v_add_f32 v119, v119, v127
    v_add_f32 v96, v96, v112
    v_add_f32 v97, v97, v113
    v_add_f32 v98, v98, v114
    v_add_f32 v99, v99, v115
    v_add_f32 v100, v100, v116
    v_add_f32 v101, v101, v117
    v_add_f32 v102, v102, v118
    v_add_f32 v103, v103, v119
    v_cvt_pk_bf16_f32 v152, v96, v97
    v_cvt_pk_bf16_f32 v153, v98, v99
    v_cvt_pk_bf16_f32 v154, v100, v101
    v_cvt_pk_bf16_f32 v155, v102, v103
    v_lshlrev_b32 v96, 16, v152
    v_and_b32 v97, 0xffff0000, v152
    v_lshlrev_b32 v98, 16, v153
    v_and_b32 v99, 0xffff0000, v153
    v_lshlrev_b32 v100, 16, v154
    v_and_b32 v101, 0xffff0000, v154
    v_lshlrev_b32 v102, 16, v155
    v_and_b32 v103, 0xffff0000, v155
    v_add_f32 v96, v96, v144
    v_add_f32 v97, v97, v145
    v_add_f32 v98, v98, v146
    v_add_f32 v99, v99, v147
    v_add_f32 v100, v100, v148
    v_add_f32 v101, v101, v149
    v_add_f32 v102, v102, v150
    v_add_f32 v103, v103, v151
    v_cvt_pk_bf16_f32 v152, v96, v97
    v_cvt_pk_bf16_f32 v153, v98, v99
    v_cvt_pk_bf16_f32 v154, v100, v101
    v_cvt_pk_bf16_f32 v155, v102, v103
    global_store_dwordx4 v43, v[152:155], s[6:7] sc0 sc1
    s_waitcnt vmcnt(0)
    s_barrier
    s_cmp_lg_u32 s14, 0
    s_cbranch_scc1 L_B_end
    s_lshl_b32 s8, s3, 2
    s_add_u32 s8, s8, 0x2000c00
    v_mov_b32 v3, s8
    v_mov_b32 v4, 1
    global_store_dword v3, v4, s[6:7] sc0 sc1
L_B_end:
L_end:
    s_endpgm
.section .rodata,"a"
.p2align 6
.amdhsa_kernel fused_kernel
  .amdhsa_next_free_vgpr 256
  .amdhsa_next_free_sgpr 100
  .amdhsa_accum_offset 256
  .amdhsa_group_segment_fixed_size 0
  .amdhsa_kernarg_size 112
  .amdhsa_user_sgpr_count 2
  .amdhsa_user_sgpr_kernarg_segment_ptr 1
  .amdhsa_system_sgpr_workgroup_id_x 1
.end_amdhsa_kernel
```
